```python
import torch

def _softmax(x, axis=-1):
    return torch.softmax(x, dim=axis)
def _gelu(x):
    return torch.nn.functional.gelu(x, approximate="tanh")
def _silu(x):
    return torch.nn.functional.silu(x)
def _sigmoid(x):
    return torch.sigmoid(x)
def _layernorm(x, axis=-1, eps=1e-5):
    m = x.mean(dim=axis, keepdim=True)
    v = x.var(dim=axis, keepdim=True, unbiased=False)
    return (x - m) / torch.sqrt(v + eps)
def _scatter_add(tgt, idx, src, axis=0):
    return tgt.clone().index_add_(axis, idx, src)
def _segment_sum(src, seg, n):
    out = torch.zeros((n,) + src.shape[1:], dtype=src.dtype)
    return out.index_add_(0, seg, src)
def _pad(x, pw):
    flat = tuple(v for pair in reversed(pw) for v in pair)
    return torch.nn.functional.pad(x, flat)

kernel_name = 'gated_mix__linear_attn_block__dense_activation_relu__prompt'

def setup_inputs():

    _w = (lambda a: (lambda t: t.to(torch.bfloat16) if t.is_floating_point() else t)(torch.as_tensor(a)))
    def _A_setup():
        B, S, D = 1, 2048, 576
        return {
            "x": _w((lambda *s: torch.randn(*s, dtype=torch.bfloat16) * 0.05)(B, S, D)),
            "wqkv": _w((lambda *s: torch.randn(*s, dtype=torch.bfloat16) * 0.8)(D, 3 * D)),
            "wo": _w((lambda *s: torch.randn(*s, dtype=torch.bfloat16) * 0.2)(D, D)),
        }
    _A_in = _A_setup()

    def _B_setup():
        B, S, D, Dff = 1, 2048, 576, 4608
        return {
            "x": _w((lambda *s: torch.randn(*s, dtype=torch.bfloat16) * 0.05)(B, S, D)),
            "w1": _w((lambda *s: torch.randn(*s, dtype=torch.bfloat16) * 0.05)(D, Dff)),
            "w2": _w((lambda *s: torch.randn(*s, dtype=torch.bfloat16) * 0.05)(Dff, D)),
        }
    _B_in = _B_setup()

    return {
        "A_x": _A_in["x"],
        "A_wqkv": _A_in["wqkv"],
        "A_wo": _A_in["wo"],
        "B_x": _B_in["x"],
        "B_w1": _B_in["w1"],
        "B_w2": _B_in["w2"],
        "gate_w": _w((lambda *s: torch.randn(*s, dtype=torch.bfloat16) * 0.05)(576) * 16.0),
    }

def reference(A_x, A_wqkv, A_wo, B_x, B_w1, B_w2, gate_w):
    def _A_ref(x, wqkv, wo):
        B, S, D = x.shape
        H = 32; Dh = D // H
        qkv = (lambda x, *d: x.permute(*d))((x @ wqkv).reshape(B, S, 3, H, Dh), 2, 0, 3, 1, 4)
        q, k, v = qkv[0], qkv[1], qkv[2]
        phi = lambda t: torch.where(t > 0, t + 1, torch.exp(t)) + 1e-6
        pq, pk = phi(q), phi(k)
        kv = torch.einsum("bhsd,bhse->bhde", pk, v)
        z = torch.einsum("bhsd->bhd", pk)
        num = torch.einsum("bhqd,bhde->bhqe", pq, kv)
        den = torch.einsum("bhqd,bhd->bhq", pq, z)[..., None] + 1e-6
        o = num / den
        return (lambda x, *d: x.permute(*d))(o, 0, 2, 1, 3).reshape(B, S, D) @ wo

    def _B_ref(x, w1, w2):
        h = torch.einsum("bsd,df->bsf", x, w1)
        zero = torch.zeros_like(h)
        h = torch.maximum(h, zero)
        return torch.einsum("bsf,fd->bsd", h, w2)

    x = A_x
    g = _sigmoid((x * gate_w).sum(-1, keepdims=True))
    a = _A_ref(x, A_wqkv, A_wo)
    b = _B_ref(x, B_w1, B_w2)
    return g * a + (1 - g) * b
```

```asm
; @launch kernel=k1_kernel grid=(704,1,1) block=(256,1,1) lds=69632
; @launch kernel=kkv_kernel grid=(512,1,1) block=(256,1,1) lds=18432
; @launch kernel=ko_kernel grid=(256,1,1) block=(256,1,1) lds=6144
; @launch kernel=k2_kernel grid=(448,1,1) block=(256,1,1) lds=69632
; @launch kernel=kfin_kernel grid=(512,1,1) block=(256,1,1) lds=0
.amdgcn_target "amdgcn-amd-amdhsa--gfx950"
.text
.globl k1_kernel
.p2align 8
.type k1_kernel,@function
k1_kernel:
    s_load_dwordx4 s[40:43], s[0:1], 0
    s_load_dwordx2 s[44:45], s[0:1], 32
    s_load_dwordx2 s[46:47], s[0:1], 72
    s_cmp_ge_u32 s2, 704
    s_cbranch_scc1 k1_done

    v_and_b32 v1, 63, v0
    v_lshrrev_b32 v11, 6, v0
    s_nop 0
    v_readfirstlane_b32 s16, v11

    s_waitcnt lgkmcnt(0)
    s_mov_b32 s4, s40
    s_mov_b32 s5, s41
    s_mov_b32 s6, 2359296
    s_mov_b32 s7, 0x00020000
    s_mov_b32 s12, s46
    s_mov_b32 s13, s47
    s_mov_b32 s14, 268435456
    s_mov_b32 s15, 0x00020000
    s_mov_b32 s24, 0
    s_mov_b32 s25, 0
    s_cmp_ge_u32 s2, 192
    s_cbranch_scc1 k1_ffn
    s_mov_b32 s8, s42
    s_mov_b32 s9, s43
    s_mov_b32 s10, 1990656
    s_mov_b32 s11, 0x00020000
    s_mul_hi_u32 s17, s2, 357913942
    s_mul_i32 s19, s17, 12
    s_sub_u32 s19, s2, s19
    s_lshl_b32 s17, s17, 7
    s_mul_i32 s18, s19, 288
    s_mov_b32 s33, 3456
    s_mov_b32 s34, 20971520

    v_lshrrev_b32 v11, 3, v1
    s_lshl_b32 s22, s16, 5
    s_add_u32 s22, s22, s17
    v_add_u32 v12, s22, v11
    s_mov_b32 s23, 1152
    v_mul_lo_u32 v2, v12, s23
    v_lshrrev_b32 v12, 1, v11
    v_and_b32 v12, 7, v12
    v_and_b32 v13, 7, v1
    v_xor_b32 v12, v12, v13
    v_lshlrev_b32 v12, 4, v12
    v_xor_b32 v13, 64, v12
    v_add_u32 v105, v2, v13
    v_add_u32 v2, v2, v12
    v_and_b32 v11, 15, v1
    v_lshrrev_b32 v12, 4, v1
    v_lshrrev_b32 v13, 1, v11
    v_and_b32 v13, 7, v13
    v_xor_b32 v14, v12, v13
    v_lshlrev_b32 v14, 4, v14
    v_xor_b32 v15, 4, v12
    v_xor_b32 v15, v15, v13
    v_lshlrev_b32 v15, 4, v15
    s_lshl_b32 s22, s16, 12
    v_lshlrev_b32 v11, 7, v11
    v_add_u32 v11, s22, v11
    v_add_u32 v11, 36864, v11
    v_add_u32 v3, v11, v14
    v_add_u32 v104, v11, v15

    s_mul_i32 s22, s16, 288
    s_add_u32 s22, s22, 0
    v_add_u32 v11, s22, v1
    s_movk_i32 s23, 3641
    v_mul_lo_u32 v12, v11, s23
    v_lshrrev_b32 v12, 16, v12
    v_mul_u32_u24 v13, 18, v12
    v_sub_u32 v13, v11, v13
    v_lshrrev_b32 v14, 3, v12
    v_and_b32 v14, 1, v14
    v_lshlrev_b32 v14, 2, v14
    v_xor_b32 v12, v12, v14
    s_mov_b32 s23, 3456
    v_mul_lo_u32 v12, v12, s23
    v_lshlrev_b32 v14, 4, v13
    v_add_u32 v12, v12, v14

    v_add_u32 v4, s18, v12
    s_mul_i32 s22, s16, 288
    s_add_u32 s22, s22, 64
    v_add_u32 v11, s22, v1
    s_movk_i32 s23, 3641
    v_mul_lo_u32 v12, v11, s23
    v_lshrrev_b32 v12, 16, v12
    v_mul_u32_u24 v13, 18, v12
    v_sub_u32 v13, v11, v13
    v_lshrrev_b32 v14, 3, v12
    v_and_b32 v14, 1, v14
    v_lshlrev_b32 v14, 2, v14
    v_xor_b32 v12, v12, v14
    s_mov_b32 s23, 3456
    v_mul_lo_u32 v12, v12, s23
    v_lshlrev_b32 v14, 4, v13
    v_add_u32 v12, v12, v14

    v_add_u32 v5, s18, v12
    s_mul_i32 s22, s16, 288
    s_add_u32 s22, s22, 128
    v_add_u32 v11, s22, v1
    s_movk_i32 s23, 3641
    v_mul_lo_u32 v12, v11, s23
    v_lshrrev_b32 v12, 16, v12
    v_mul_u32_u24 v13, 18, v12
    v_sub_u32 v13, v11, v13
    v_lshrrev_b32 v14, 3, v12
    v_and_b32 v14, 1, v14
    v_lshlrev_b32 v14, 2, v14
    v_xor_b32 v12, v12, v14
    s_mov_b32 s23, 3456
    v_mul_lo_u32 v12, v12, s23
    v_lshlrev_b32 v14, 4, v13
    v_add_u32 v12, v12, v14

    v_add_u32 v6, s18, v12
    s_mul_i32 s22, s16, 288
    s_add_u32 s22, s22, 192
    v_add_u32 v11, s22, v1
    s_movk_i32 s23, 3641
    v_mul_lo_u32 v12, v11, s23
    v_lshrrev_b32 v12, 16, v12
    v_mul_u32_u24 v13, 18, v12
    v_sub_u32 v13, v11, v13
    v_lshrrev_b32 v14, 3, v12
    v_and_b32 v14, 1, v14
    v_lshlrev_b32 v14, 2, v14
    v_xor_b32 v12, v12, v14
    s_mov_b32 s23, 3456
    v_mul_lo_u32 v12, v12, s23
    v_lshlrev_b32 v14, 4, v13
    v_add_u32 v12, v12, v14

    v_add_u32 v7, s18, v12
    s_mul_i32 s22, s16, 288
    s_add_u32 s22, s22, 256
    v_add_u32 v11, s22, v1
    s_movk_i32 s23, 3641
    v_mul_lo_u32 v12, v11, s23
    v_lshrrev_b32 v12, 16, v12
    v_mul_u32_u24 v13, 18, v12
    v_sub_u32 v13, v11, v13
    v_lshrrev_b32 v14, 3, v12
    v_and_b32 v14, 1, v14
    v_lshlrev_b32 v14, 2, v14
    v_xor_b32 v12, v12, v14
    s_mov_b32 s23, 3456
    v_mul_lo_u32 v12, v12, s23
    v_lshlrev_b32 v14, 4, v13
    v_add_u32 v12, v12, v14

    v_add_u32 v8, s18, v12
    v_lshrrev_b32 v11, 4, v1
    v_and_b32 v12, 15, v1
    v_lshrrev_b32 v13, 2, v12
    v_and_b32 v14, 3, v12
    v_and_b32 v15, 1, v11
    v_lshlrev_b32 v15, 2, v15
    v_lshlrev_b32 v11, 3, v11
    v_add_u32 v11, v11, v13
    v_add_u32 v12, v11, v15
    v_mul_u32_u24 v12, 288, v12
    v_lshlrev_b32 v14, 3, v14
    v_add_u32 v9, v12, v14
    v_xor_b32 v15, 4, v15
    v_add_u32 v12, v11, v15
    v_mul_u32_u24 v12, 288, v12
    v_add_u32 v10, v12, v14

    v_accvgpr_write_b32 a0, 0
    v_accvgpr_write_b32 a1, 0
    v_accvgpr_write_b32 a2, 0
    v_accvgpr_write_b32 a3, 0
    v_accvgpr_write_b32 a4, 0
    v_accvgpr_write_b32 a5, 0
    v_accvgpr_write_b32 a6, 0
    v_accvgpr_write_b32 a7, 0
    v_accvgpr_write_b32 a8, 0
    v_accvgpr_write_b32 a9, 0
    v_accvgpr_write_b32 a10, 0
    v_accvgpr_write_b32 a11, 0
    v_accvgpr_write_b32 a12, 0
    v_accvgpr_write_b32 a13, 0
    v_accvgpr_write_b32 a14, 0
    v_accvgpr_write_b32 a15, 0
    v_accvgpr_write_b32 a16, 0
    v_accvgpr_write_b32 a17, 0
    v_accvgpr_write_b32 a18, 0
    v_accvgpr_write_b32 a19, 0
    v_accvgpr_write_b32 a20, 0
    v_accvgpr_write_b32 a21, 0
    v_accvgpr_write_b32 a22, 0
    v_accvgpr_write_b32 a23, 0
    v_accvgpr_write_b32 a24, 0
    v_accvgpr_write_b32 a25, 0
    v_accvgpr_write_b32 a26, 0
    v_accvgpr_write_b32 a27, 0
    v_accvgpr_write_b32 a28, 0
    v_accvgpr_write_b32 a29, 0
    v_accvgpr_write_b32 a30, 0
    v_accvgpr_write_b32 a31, 0
    v_accvgpr_write_b32 a32, 0
    v_accvgpr_write_b32 a33, 0
    v_accvgpr_write_b32 a34, 0
    v_accvgpr_write_b32 a35, 0
    v_accvgpr_write_b32 a36, 0
    v_accvgpr_write_b32 a37, 0
    v_accvgpr_write_b32 a38, 0
    v_accvgpr_write_b32 a39, 0
    v_accvgpr_write_b32 a40, 0
    v_accvgpr_write_b32 a41, 0
    v_accvgpr_write_b32 a42, 0
    v_accvgpr_write_b32 a43, 0
    v_accvgpr_write_b32 a44, 0
    v_accvgpr_write_b32 a45, 0
    v_accvgpr_write_b32 a46, 0
    v_accvgpr_write_b32 a47, 0
    v_accvgpr_write_b32 a48, 0
    v_accvgpr_write_b32 a49, 0
    v_accvgpr_write_b32 a50, 0
    v_accvgpr_write_b32 a51, 0
    v_accvgpr_write_b32 a52, 0
    v_accvgpr_write_b32 a53, 0
    v_accvgpr_write_b32 a54, 0
    v_accvgpr_write_b32 a55, 0
    v_accvgpr_write_b32 a56, 0
    v_accvgpr_write_b32 a57, 0
    v_accvgpr_write_b32 a58, 0
    v_accvgpr_write_b32 a59, 0
    v_accvgpr_write_b32 a60, 0
    v_accvgpr_write_b32 a61, 0
    v_accvgpr_write_b32 a62, 0
    v_accvgpr_write_b32 a63, 0
    v_accvgpr_write_b32 a64, 0
    v_accvgpr_write_b32 a65, 0
    v_accvgpr_write_b32 a66, 0
    v_accvgpr_write_b32 a67, 0
    v_accvgpr_write_b32 a68, 0
    v_accvgpr_write_b32 a69, 0
    v_accvgpr_write_b32 a70, 0
    v_accvgpr_write_b32 a71, 0
    s_mul_i32 s26, s16, 4608
    s_lshl_b32 s31, s16, 12
    s_mov_b32 s29, 0x7ffffff0
    s_mov_b32 s28, 9
    s_mov_b32 s30, 9

    s_cmp_gt_i32 s28, 0
    s_cselect_b32 s22, s25, s29
    s_cselect_b32 s23, s24, s29
    s_add_u32 m0, s31, 36864
    s_add_u32 s27, s23, 0
    buffer_load_dwordx4 v2, s[4:7], s27 offen lds
    s_add_u32 m0, s31, 37888
    s_add_u32 s27, s23, 9216
    buffer_load_dwordx4 v105, s[4:7], s27 offen lds
    s_add_u32 m0, s31, 38912
    s_add_u32 s27, s23, 18432
    buffer_load_dwordx4 v2, s[4:7], s27 offen lds
    s_add_u32 m0, s31, 39936
    s_add_u32 s27, s23, 27648
    buffer_load_dwordx4 v105, s[4:7], s27 offen lds
    s_add_u32 m0, s26, 0
    s_nop 0
    buffer_load_dwordx4 v4, s[8:11], s22 offen lds
    s_add_u32 m0, s26, 1024
    s_nop 0
    buffer_load_dwordx4 v5, s[8:11], s22 offen lds
    s_add_u32 m0, s26, 2048
    s_nop 0
    buffer_load_dwordx4 v6, s[8:11], s22 offen lds
    s_add_u32 m0, s26, 3072
    s_nop 0
    buffer_load_dwordx4 v7, s[8:11], s22 offen lds
    s_add_u32 m0, s26, 4096
    s_mov_b64 exec, 0xffffffff
    buffer_load_dwordx4 v8, s[8:11], s22 offen lds
    s_mov_b64 exec, -1
    s_add_u32 s25, s25, 221184
    s_add_u32 s24, s24, 128
    s_sub_u32 s28, s28, 1
Lloop_1:
    s_waitcnt vmcnt(0)
    s_barrier
    s_cmp_gt_i32 s28, 0
    s_cselect_b32 s22, s25, s29
    s_cselect_b32 s23, s24, s29
    s_add_u32 m0, s31, 53248
    s_add_u32 s27, s23, 0
    buffer_load_dwordx4 v2, s[4:7], s27 offen lds
    s_add_u32 m0, s31, 54272
    s_add_u32 s27, s23, 9216
    buffer_load_dwordx4 v105, s[4:7], s27 offen lds
    s_add_u32 m0, s31, 55296
    s_add_u32 s27, s23, 18432
    buffer_load_dwordx4 v2, s[4:7], s27 offen lds
    s_add_u32 m0, s31, 56320
    s_add_u32 s27, s23, 27648
    buffer_load_dwordx4 v105, s[4:7], s27 offen lds
    s_add_u32 m0, s26, 18432
    s_nop 0
    buffer_load_dwordx4 v4, s[8:11], s22 offen lds
    s_add_u32 m0, s26, 19456
    s_nop 0
    buffer_load_dwordx4 v5, s[8:11], s22 offen lds
    s_add_u32 m0, s26, 20480
    s_nop 0
    buffer_load_dwordx4 v6, s[8:11], s22 offen lds
    s_add_u32 m0, s26, 21504
    s_nop 0
    buffer_load_dwordx4 v7, s[8:11], s22 offen lds
    s_add_u32 m0, s26, 22528
    s_mov_b64 exec, 0xffffffff
    buffer_load_dwordx4 v8, s[8:11], s22 offen lds
    s_mov_b64 exec, -1
    s_add_u32 s25, s25, 221184
    s_add_u32 s24, s24, 128
    s_sub_u32 s28, s28, 1
    ds_read_b128 v[16:19], v3 offset:0
    ds_read_b128 v[20:23], v104 offset:0
    ds_read_b128 v[24:27], v3 offset:2048
    ds_read_b128 v[28:31], v104 offset:2048
    ds_read_b64_tr_b16 v[80:81], v9 offset:0
    ds_read_b64_tr_b16 v[82:83], v10 offset:0
    ds_read_b64_tr_b16 v[84:85], v9 offset:32
    ds_read_b64_tr_b16 v[86:87], v10 offset:32
    ds_read_b64_tr_b16 v[88:89], v9 offset:64
    ds_read_b64_tr_b16 v[90:91], v10 offset:64
    ds_read_b64_tr_b16 v[92:93], v9 offset:96
    ds_read_b64_tr_b16 v[94:95], v10 offset:96
    ds_read_b64_tr_b16 v[96:97], v9 offset:128
    ds_read_b64_tr_b16 v[98:99], v10 offset:128
    s_waitcnt lgkmcnt(8)
    v_mfma_f32_16x16x32_bf16 a[0:3], v[80:83], v[16:19], a[0:3]
    v_mfma_f32_16x16x32_bf16 a[36:39], v[80:83], v[24:27], a[36:39]
    ds_read_b64_tr_b16 v[100:101], v9 offset:160
    ds_read_b64_tr_b16 v[102:103], v10 offset:160
    s_waitcnt lgkmcnt(8)
    v_mfma_f32_16x16x32_bf16 a[4:7], v[84:87], v[16:19], a[4:7]
    v_mfma_f32_16x16x32_bf16 a[40:43], v[84:87], v[24:27], a[40:43]
    ds_read_b64_tr_b16 v[80:81], v9 offset:192
    ds_read_b64_tr_b16 v[82:83], v10 offset:192
    s_waitcnt lgkmcnt(8)
    v_mfma_f32_16x16x32_bf16 a[8:11], v[88:91], v[16:19], a[8:11]
    v_mfma_f32_16x16x32_bf16 a[44:47], v[88:91], v[24:27], a[44:47]
    ds_read_b64_tr_b16 v[84:85], v9 offset:224
    ds_read_b64_tr_b16 v[86:87], v10 offset:224
    s_waitcnt lgkmcnt(8)
    v_mfma_f32_16x16x32_bf16 a[12:15], v[92:95], v[16:19], a[12:15]
    v_mfma_f32_16x16x32_bf16 a[48:51], v[92:95], v[24:27], a[48:51]
    ds_read_b64_tr_b16 v[88:89], v9 offset:256
    ds_read_b64_tr_b16 v[90:91], v10 offset:256
    s_waitcnt lgkmcnt(8)
    v_mfma_f32_16x16x32_bf16 a[16:19], v[96:99], v[16:19], a[16:19]
    v_mfma_f32_16x16x32_bf16 a[52:55], v[96:99], v[24:27], a[52:55]
    ds_read_b64_tr_b16 v[92:93], v9 offset:9216
    ds_read_b64_tr_b16 v[94:95], v10 offset:9216
    s_waitcnt lgkmcnt(8)
    v_mfma_f32_16x16x32_bf16 a[20:23], v[100:103], v[16:19], a[20:23]
    v_mfma_f32_16x16x32_bf16 a[56:59], v[100:103], v[24:27], a[56:59]
    ds_read_b64_tr_b16 v[96:97], v9 offset:9248
    ds_read_b64_tr_b16 v[98:99], v10 offset:9248
    s_waitcnt lgkmcnt(8)
    v_mfma_f32_16x16x32_bf16 a[24:27], v[80:83], v[16:19], a[24:27]
    v_mfma_f32_16x16x32_bf16 a[60:63], v[80:83], v[24:27], a[60:63]
    ds_read_b64_tr_b16 v[100:101], v9 offset:9280
    ds_read_b64_tr_b16 v[102:103], v10 offset:9280
    s_waitcnt lgkmcnt(8)
    v_mfma_f32_16x16x32_bf16 a[28:31], v[84:87], v[16:19], a[28:31]
    v_mfma_f32_16x16x32_bf16 a[64:67], v[84:87], v[24:27], a[64:67]
    ds_read_b64_tr_b16 v[80:81], v9 offset:9312
    ds_read_b64_tr_b16 v[82:83], v10 offset:9312
    s_waitcnt lgkmcnt(8)
    v_mfma_f32_16x16x32_bf16 a[32:35], v[88:91], v[16:19], a[32:35]
    v_mfma_f32_16x16x32_bf16 a[68:71], v[88:91], v[24:27], a[68:71]
    ds_read_b64_tr_b16 v[84:85], v9 offset:9344
    ds_read_b64_tr_b16 v[86:87], v10 offset:9344
    s_waitcnt lgkmcnt(8)
    v_mfma_f32_16x16x32_bf16 a[0:3], v[92:95], v[20:23], a[0:3]
    v_mfma_f32_16x16x32_bf16 a[36:39], v[92:95], v[28:31], a[36:39]
    ds_read_b64_tr_b16 v[88:89], v9 offset:9376
    ds_read_b64_tr_b16 v[90:91], v10 offset:9376
    s_waitcnt lgkmcnt(8)
    v_mfma_f32_16x16x32_bf16 a[4:7], v[96:99], v[20:23], a[4:7]
    v_mfma_f32_16x16x32_bf16 a[40:43], v[96:99], v[28:31], a[40:43]
    ds_read_b64_tr_b16 v[92:93], v9 offset:9408
    ds_read_b64_tr_b16 v[94:95], v10 offset:9408
    s_waitcnt lgkmcnt(8)
    v_mfma_f32_16x16x32_bf16 a[8:11], v[100:103], v[20:23], a[8:11]
    v_mfma_f32_16x16x32_bf16 a[44:47], v[100:103], v[28:31], a[44:47]
    ds_read_b64_tr_b16 v[96:97], v9 offset:9440
    ds_read_b64_tr_b16 v[98:99], v10 offset:9440
    s_waitcnt lgkmcnt(8)
    v_mfma_f32_16x16x32_bf16 a[12:15], v[80:83], v[20:23], a[12:15]
    v_mfma_f32_16x16x32_bf16 a[48:51], v[80:83], v[28:31], a[48:51]
    ds_read_b64_tr_b16 v[100:101], v9 offset:9472
    ds_read_b64_tr_b16 v[102:103], v10 offset:9472
    s_waitcnt lgkmcnt(8)
    v_mfma_f32_16x16x32_bf16 a[16:19], v[84:87], v[20:23], a[16:19]
    v_mfma_f32_16x16x32_bf16 a[52:55], v[84:87], v[28:31], a[52:55]
    s_waitcnt lgkmcnt(6)
    v_mfma_f32_16x16x32_bf16 a[20:23], v[88:91], v[20:23], a[20:23]
    v_mfma_f32_16x16x32_bf16 a[56:59], v[88:91], v[28:31], a[56:59]
    s_waitcnt lgkmcnt(4)
    v_mfma_f32_16x16x32_bf16 a[24:27], v[92:95], v[20:23], a[24:27]
    v_mfma_f32_16x16x32_bf16 a[60:63], v[92:95], v[28:31], a[60:63]
    s_waitcnt lgkmcnt(2)
    v_mfma_f32_16x16x32_bf16 a[28:31], v[96:99], v[20:23], a[28:31]
    v_mfma_f32_16x16x32_bf16 a[64:67], v[96:99], v[28:31], a[64:67]
    s_waitcnt lgkmcnt(0)
    v_mfma_f32_16x16x32_bf16 a[32:35], v[100:103], v[20:23], a[32:35]
    v_mfma_f32_16x16x32_bf16 a[68:71], v[100:103], v[28:31], a[68:71]
    s_sub_u32 s30, s30, 1
    s_cmp_eq_u32 s30, 0
    s_cbranch_scc1 Lend_2
    s_waitcnt vmcnt(0)
    s_barrier
    s_cmp_gt_i32 s28, 0
    s_cselect_b32 s22, s25, s29
    s_cselect_b32 s23, s24, s29
    s_add_u32 m0, s31, 36864
    s_add_u32 s27, s23, 0
    buffer_load_dwordx4 v2, s[4:7], s27 offen lds
    s_add_u32 m0, s31, 37888
    s_add_u32 s27, s23, 9216
    buffer_load_dwordx4 v105, s[4:7], s27 offen lds
    s_add_u32 m0, s31, 38912
    s_add_u32 s27, s23, 18432
    buffer_load_dwordx4 v2, s[4:7], s27 offen lds
    s_add_u32 m0, s31, 39936
    s_add_u32 s27, s23, 27648
    buffer_load_dwordx4 v105, s[4:7], s27 offen lds
    s_add_u32 m0, s26, 0
    s_nop 0
    buffer_load_dwordx4 v4, s[8:11], s22 offen lds
    s_add_u32 m0, s26, 1024
    s_nop 0
    buffer_load_dwordx4 v5, s[8:11], s22 offen lds
    s_add_u32 m0, s26, 2048
    s_nop 0
    buffer_load_dwordx4 v6, s[8:11], s22 offen lds
    s_add_u32 m0, s26, 3072
    s_nop 0
    buffer_load_dwordx4 v7, s[8:11], s22 offen lds
    s_add_u32 m0, s26, 4096
    s_mov_b64 exec, 0xffffffff
    buffer_load_dwordx4 v8, s[8:11], s22 offen lds
    s_mov_b64 exec, -1
    s_add_u32 s25, s25, 221184
    s_add_u32 s24, s24, 128
    s_sub_u32 s28, s28, 1
    ds_read_b128 v[16:19], v3 offset:16384
    ds_read_b128 v[20:23], v104 offset:16384
    ds_read_b128 v[24:27], v3 offset:18432
    ds_read_b128 v[28:31], v104 offset:18432
    ds_read_b64_tr_b16 v[80:81], v9 offset:18432
    ds_read_b64_tr_b16 v[82:83], v10 offset:18432
    ds_read_b64_tr_b16 v[84:85], v9 offset:18464
    ds_read_b64_tr_b16 v[86:87], v10 offset:18464
    ds_read_b64_tr_b16 v[88:89], v9 offset:18496
    ds_read_b64_tr_b16 v[90:91], v10 offset:18496
    ds_read_b64_tr_b16 v[92:93], v9 offset:18528
    ds_read_b64_tr_b16 v[94:95], v10 offset:18528
    ds_read_b64_tr_b16 v[96:97], v9 offset:18560
    ds_read_b64_tr_b16 v[98:99], v10 offset:18560
    s_waitcnt lgkmcnt(8)
    v_mfma_f32_16x16x32_bf16 a[0:3], v[80:83], v[16:19], a[0:3]
    v_mfma_f32_16x16x32_bf16 a[36:39], v[80:83], v[24:27], a[36:39]
    ds_read_b64_tr_b16 v[100:101], v9 offset:18592
    ds_read_b64_tr_b16 v[102:103], v10 offset:18592
    s_waitcnt lgkmcnt(8)
    v_mfma_f32_16x16x32_bf16 a[4:7], v[84:87], v[16:19], a[4:7]
    v_mfma_f32_16x16x32_bf16 a[40:43], v[84:87], v[24:27], a[40:43]
    ds_read_b64_tr_b16 v[80:81], v9 offset:18624
    ds_read_b64_tr_b16 v[82:83], v10 offset:18624
    s_waitcnt lgkmcnt(8)
    v_mfma_f32_16x16x32_bf16 a[8:11], v[88:91], v[16:19], a[8:11]
    v_mfma_f32_16x16x32_bf16 a[44:47], v[88:91], v[24:27], a[44:47]
    ds_read_b64_tr_b16 v[84:85], v9 offset:18656
    ds_read_b64_tr_b16 v[86:87], v10 offset:18656
    s_waitcnt lgkmcnt(8)
    v_mfma_f32_16x16x32_bf16 a[12:15], v[92:95], v[16:19], a[12:15]
    v_mfma_f32_16x16x32_bf16 a[48:51], v[92:95], v[24:27], a[48:51]
    ds_read_b64_tr_b16 v[88:89], v9 offset:18688
    ds_read_b64_tr_b16 v[90:91], v10 offset:18688
    s_waitcnt lgkmcnt(8)
    v_mfma_f32_16x16x32_bf16 a[16:19], v[96:99], v[16:19], a[16:19]
    v_mfma_f32_16x16x32_bf16 a[52:55], v[96:99], v[24:27], a[52:55]
    ds_read_b64_tr_b16 v[92:93], v9 offset:27648
    ds_read_b64_tr_b16 v[94:95], v10 offset:27648
    s_waitcnt lgkmcnt(8)
    v_mfma_f32_16x16x32_bf16 a[20:23], v[100:103], v[16:19], a[20:23]
    v_mfma_f32_16x16x32_bf16 a[56:59], v[100:103], v[24:27], a[56:59]
    ds_read_b64_tr_b16 v[96:97], v9 offset:27680
    ds_read_b64_tr_b16 v[98:99], v10 offset:27680
    s_waitcnt lgkmcnt(8)
    v_mfma_f32_16x16x32_bf16 a[24:27], v[80:83], v[16:19], a[24:27]
    v_mfma_f32_16x16x32_bf16 a[60:63], v[80:83], v[24:27], a[60:63]
    ds_read_b64_tr_b16 v[100:101], v9 offset:27712
    ds_read_b64_tr_b16 v[102:103], v10 offset:27712
    s_waitcnt lgkmcnt(8)
    v_mfma_f32_16x16x32_bf16 a[28:31], v[84:87], v[16:19], a[28:31]
    v_mfma_f32_16x16x32_bf16 a[64:67], v[84:87], v[24:27], a[64:67]
    ds_read_b64_tr_b16 v[80:81], v9 offset:27744
    ds_read_b64_tr_b16 v[82:83], v10 offset:27744
    s_waitcnt lgkmcnt(8)
    v_mfma_f32_16x16x32_bf16 a[32:35], v[88:91], v[16:19], a[32:35]
    v_mfma_f32_16x16x32_bf16 a[68:71], v[88:91], v[24:27], a[68:71]
    ds_read_b64_tr_b16 v[84:85], v9 offset:27776
    ds_read_b64_tr_b16 v[86:87], v10 offset:27776
    s_waitcnt lgkmcnt(8)
    v_mfma_f32_16x16x32_bf16 a[0:3], v[92:95], v[20:23], a[0:3]
    v_mfma_f32_16x16x32_bf16 a[36:39], v[92:95], v[28:31], a[36:39]
    ds_read_b64_tr_b16 v[88:89], v9 offset:27808
    ds_read_b64_tr_b16 v[90:91], v10 offset:27808
    s_waitcnt lgkmcnt(8)
    v_mfma_f32_16x16x32_bf16 a[4:7], v[96:99], v[20:23], a[4:7]
    v_mfma_f32_16x16x32_bf16 a[40:43], v[96:99], v[28:31], a[40:43]
    ds_read_b64_tr_b16 v[92:93], v9 offset:27840
    ds_read_b64_tr_b16 v[94:95], v10 offset:27840
    s_waitcnt lgkmcnt(8)
    v_mfma_f32_16x16x32_bf16 a[8:11], v[100:103], v[20:23], a[8:11]
    v_mfma_f32_16x16x32_bf16 a[44:47], v[100:103], v[28:31], a[44:47]
    ds_read_b64_tr_b16 v[96:97], v9 offset:27872
    ds_read_b64_tr_b16 v[98:99], v10 offset:27872
    s_waitcnt lgkmcnt(8)
    v_mfma_f32_16x16x32_bf16 a[12:15], v[80:83], v[20:23], a[12:15]
    v_mfma_f32_16x16x32_bf16 a[48:51], v[80:83], v[28:31], a[48:51]
    ds_read_b64_tr_b16 v[100:101], v9 offset:27904
    ds_read_b64_tr_b16 v[102:103], v10 offset:27904
    s_waitcnt lgkmcnt(8)
    v_mfma_f32_16x16x32_bf16 a[16:19], v[84:87], v[20:23], a[16:19]
    v_mfma_f32_16x16x32_bf16 a[52:55], v[84:87], v[28:31], a[52:55]
    s_waitcnt lgkmcnt(6)
    v_mfma_f32_16x16x32_bf16 a[20:23], v[88:91], v[20:23], a[20:23]
    v_mfma_f32_16x16x32_bf16 a[56:59], v[88:91], v[28:31], a[56:59]
    s_waitcnt lgkmcnt(4)
    v_mfma_f32_16x16x32_bf16 a[24:27], v[92:95], v[20:23], a[24:27]
    v_mfma_f32_16x16x32_bf16 a[60:63], v[92:95], v[28:31], a[60:63]
    s_waitcnt lgkmcnt(2)
    v_mfma_f32_16x16x32_bf16 a[28:31], v[96:99], v[20:23], a[28:31]
    v_mfma_f32_16x16x32_bf16 a[64:67], v[96:99], v[28:31], a[64:67]
    s_waitcnt lgkmcnt(0)
    v_mfma_f32_16x16x32_bf16 a[32:35], v[100:103], v[20:23], a[32:35]
    v_mfma_f32_16x16x32_bf16 a[68:71], v[100:103], v[28:31], a[68:71]
    s_sub_u32 s30, s30, 1
    s_cmp_eq_u32 s30, 0
    s_cbranch_scc0 Lloop_1
Lend_2:
    s_waitcnt vmcnt(0)
    s_nop 7
    s_nop 7
    v_and_b32 v11, 15, v1
    s_lshl_b32 s22, s16, 5
    s_add_u32 s22, s22, s17
    v_add_u32 v11, s22, v11
    v_mul_lo_u32 v12, v11, s33
    v_lshrrev_b32 v13, 4, v1
    v_lshlrev_b32 v13, 3, v13
    v_add_u32 v12, v12, v13
    v_add_u32 v12, s18, v12
    v_add_u32 v12, s34, v12
    s_lshl_b32 s22, s33, 4
    v_add_u32 v13, s22, v12

    s_nop 1
    v_accvgpr_read_b32 v16, a0
    v_accvgpr_read_b32 v17, a1
    v_accvgpr_read_b32 v18, a2
    v_accvgpr_read_b32 v19, a3

    v_cvt_pk_bf16_f32 v20, v16, v17
    v_cvt_pk_bf16_f32 v21, v18, v19
    buffer_store_dwordx2 v[20:21], v12, s[12:15], 0 offen offset:0

    s_nop 1
    v_accvgpr_read_b32 v24, a4
    v_accvgpr_read_b32 v25, a5
    v_accvgpr_read_b32 v26, a6
    v_accvgpr_read_b32 v27, a7

    v_cvt_pk_bf16_f32 v28, v24, v25
    v_cvt_pk_bf16_f32 v29, v26, v27
    buffer_store_dwordx2 v[28:29], v12, s[12:15], 0 offen offset:32

    s_nop 1
    v_accvgpr_read_b32 v32, a8
    v_accvgpr_read_b32 v33, a9
    v_accvgpr_read_b32 v34, a10
    v_accvgpr_read_b32 v35, a11

    v_cvt_pk_bf16_f32 v36, v32, v33
    v_cvt_pk_bf16_f32 v37, v34, v35
    buffer_store_dwordx2 v[36:37], v12, s[12:15], 0 offen offset:64

    s_nop 1
    v_accvgpr_read_b32 v40, a12
    v_accvgpr_read_b32 v41, a13
    v_accvgpr_read_b32 v42, a14
    v_accvgpr_read_b32 v43, a15

    v_cvt_pk_bf16_f32 v44, v40, v41
    v_cvt_pk_bf16_f32 v45, v42, v43
    buffer_store_dwordx2 v[44:45], v12, s[12:15], 0 offen offset:96

    s_nop 1
    v_accvgpr_read_b32 v16, a16
    v_accvgpr_read_b32 v17, a17
    v_accvgpr_read_b32 v18, a18
    v_accvgpr_read_b32 v19, a19

    v_cvt_pk_bf16_f32 v20, v16, v17
    v_cvt_pk_bf16_f32 v21, v18, v19
    buffer_store_dwordx2 v[20:21], v12, s[12:15], 0 offen offset:128

    s_nop 1
    v_accvgpr_read_b32 v24, a20
    v_accvgpr_read_b32 v25, a21
    v_accvgpr_read_b32 v26, a22
    v_accvgpr_read_b32 v27, a23

    v_cvt_pk_bf16_f32 v28, v24, v25
    v_cvt_pk_bf16_f32 v29, v26, v27
    buffer_store_dwordx2 v[28:29], v12, s[12:15], 0 offen offset:160

    s_nop 1
    v_accvgpr_read_b32 v32, a24
    v_accvgpr_read_b32 v33, a25
    v_accvgpr_read_b32 v34, a26
    v_accvgpr_read_b32 v35, a27

    v_cvt_pk_bf16_f32 v36, v32, v33
    v_cvt_pk_bf16_f32 v37, v34, v35
    buffer_store_dwordx2 v[36:37], v12, s[12:15], 0 offen offset:192

    s_nop 1
    v_accvgpr_read_b32 v40, a28
    v_accvgpr_read_b32 v41, a29
    v_accvgpr_read_b32 v42, a30
    v_accvgpr_read_b32 v43, a31

    v_cvt_pk_bf16_f32 v44, v40, v41
    v_cvt_pk_bf16_f32 v45, v42, v43
    buffer_store_dwordx2 v[44:45], v12, s[12:15], 0 offen offset:224

    s_nop 1
    v_accvgpr_read_b32 v16, a32
    v_accvgpr_read_b32 v17, a33
    v_accvgpr_read_b32 v18, a34
    v_accvgpr_read_b32 v19, a35

    v_cvt_pk_bf16_f32 v20, v16, v17
    v_cvt_pk_bf16_f32 v21, v18, v19
    buffer_store_dwordx2 v[20:21], v12, s[12:15], 0 offen offset:256

    s_nop 1
    v_accvgpr_read_b32 v16, a36
    v_accvgpr_read_b32 v17, a37
    v_accvgpr_read_b32 v18, a38
    v_accvgpr_read_b32 v19, a39

    v_cvt_pk_bf16_f32 v20, v16, v17
    v_cvt_pk_bf16_f32 v21, v18, v19
    buffer_store_dwordx2 v[20:21], v13, s[12:15], 0 offen offset:0

    s_nop 1
    v_accvgpr_read_b32 v24, a40
    v_accvgpr_read_b32 v25, a41
    v_accvgpr_read_b32 v26, a42
    v_accvgpr_read_b32 v27, a43

    v_cvt_pk_bf16_f32 v28, v24, v25
    v_cvt_pk_bf16_f32 v29, v26, v27
    buffer_store_dwordx2 v[28:29], v13, s[12:15], 0 offen offset:32

    s_nop 1
    v_accvgpr_read_b32 v32, a44
    v_accvgpr_read_b32 v33, a45
    v_accvgpr_read_b32 v34, a46
    v_accvgpr_read_b32 v35, a47

    v_cvt_pk_bf16_f32 v36, v32, v33
    v_cvt_pk_bf16_f32 v37, v34, v35
    buffer_store_dwordx2 v[36:37], v13, s[12:15], 0 offen offset:64

    s_nop 1
    v_accvgpr_read_b32 v40, a48
    v_accvgpr_read_b32 v41, a49
    v_accvgpr_read_b32 v42, a50
    v_accvgpr_read_b32 v43, a51

    v_cvt_pk_bf16_f32 v44, v40, v41
    v_cvt_pk_bf16_f32 v45, v42, v43
    buffer_store_dwordx2 v[44:45], v13, s[12:15], 0 offen offset:96

    s_nop 1
    v_accvgpr_read_b32 v16, a52
    v_accvgpr_read_b32 v17, a53
    v_accvgpr_read_b32 v18, a54
    v_accvgpr_read_b32 v19, a55

    v_cvt_pk_bf16_f32 v20, v16, v17
    v_cvt_pk_bf16_f32 v21, v18, v19
    buffer_store_dwordx2 v[20:21], v13, s[12:15], 0 offen offset:128

    s_nop 1
    v_accvgpr_read_b32 v24, a56
    v_accvgpr_read_b32 v25, a57
    v_accvgpr_read_b32 v26, a58
    v_accvgpr_read_b32 v27, a59

    v_cvt_pk_bf16_f32 v28, v24, v25
    v_cvt_pk_bf16_f32 v29, v26, v27
    buffer_store_dwordx2 v[28:29], v13, s[12:15], 0 offen offset:160

    s_nop 1
    v_accvgpr_read_b32 v32, a60
    v_accvgpr_read_b32 v33, a61
    v_accvgpr_read_b32 v34, a62
    v_accvgpr_read_b32 v35, a63

    v_cvt_pk_bf16_f32 v36, v32, v33
    v_cvt_pk_bf16_f32 v37, v34, v35
    buffer_store_dwordx2 v[36:37], v13, s[12:15], 0 offen offset:192

    s_nop 1
    v_accvgpr_read_b32 v40, a64
    v_accvgpr_read_b32 v41, a65
    v_accvgpr_read_b32 v42, a66
    v_accvgpr_read_b32 v43, a67

    v_cvt_pk_bf16_f32 v44, v40, v41
    v_cvt_pk_bf16_f32 v45, v42, v43
    buffer_store_dwordx2 v[44:45], v13, s[12:15], 0 offen offset:224

    s_nop 1
    v_accvgpr_read_b32 v16, a68
    v_accvgpr_read_b32 v17, a69
    v_accvgpr_read_b32 v18, a70
    v_accvgpr_read_b32 v19, a71

    v_cvt_pk_bf16_f32 v20, v16, v17
    v_cvt_pk_bf16_f32 v21, v18, v19
    buffer_store_dwordx2 v[20:21], v13, s[12:15], 0 offen offset:256

    s_branch k1_done
k1_ffn:
    s_mov_b32 s8, s44
    s_mov_b32 s9, s45
    s_mov_b32 s10, 5308416
    s_mov_b32 s11, 0x00020000
    s_sub_u32 s3, s2, 192
    s_and_b32 s19, s3, 31
    s_lshr_b32 s17, s3, 5
    s_lshl_b32 s17, s17, 7
    s_mul_i32 s18, s19, 288
    s_mov_b32 s33, 9216
    s_mov_b32 s34, 0

    v_lshrrev_b32 v11, 3, v1
    s_lshl_b32 s22, s16, 5
    s_add_u32 s22, s22, s17
    v_add_u32 v12, s22, v11
    s_mov_b32 s23, 1152
    v_mul_lo_u32 v2, v12, s23
    v_lshrrev_b32 v12, 1, v11
    v_and_b32 v12, 7, v12
    v_and_b32 v13, 7, v1
    v_xor_b32 v12, v12, v13
    v_lshlrev_b32 v12, 4, v12
    v_xor_b32 v13, 64, v12
    v_add_u32 v105, v2, v13
    v_add_u32 v2, v2, v12
    v_and_b32 v11, 15, v1
    v_lshrrev_b32 v12, 4, v1
    v_lshrrev_b32 v13, 1, v11
    v_and_b32 v13, 7, v13
    v_xor_b32 v14, v12, v13
    v_lshlrev_b32 v14, 4, v14
    v_xor_b32 v15, 4, v12
    v_xor_b32 v15, v15, v13
    v_lshlrev_b32 v15, 4, v15
    s_lshl_b32 s22, s16, 12
    v_lshlrev_b32 v11, 7, v11
    v_add_u32 v11, s22, v11
    v_add_u32 v11, 36864, v11
    v_add_u32 v3, v11, v14
    v_add_u32 v104, v11, v15

    s_mul_i32 s22, s16, 288
    s_add_u32 s22, s22, 0
    v_add_u32 v11, s22, v1
    s_movk_i32 s23, 3641
    v_mul_lo_u32 v12, v11, s23
    v_lshrrev_b32 v12, 16, v12
    v_mul_u32_u24 v13, 18, v12
    v_sub_u32 v13, v11, v13
    v_lshrrev_b32 v14, 3, v12
    v_and_b32 v14, 1, v14
    v_lshlrev_b32 v14, 2, v14
    v_xor_b32 v12, v12, v14
    s_mov_b32 s23, 9216
    v_mul_lo_u32 v12, v12, s23
    v_lshlrev_b32 v14, 4, v13
    v_add_u32 v12, v12, v14

    v_add_u32 v4, s18, v12
    s_mul_i32 s22, s16, 288
    s_add_u32 s22, s22, 64
    v_add_u32 v11, s22, v1
    s_movk_i32 s23, 3641
    v_mul_lo_u32 v12, v11, s23
    v_lshrrev_b32 v12, 16, v12
    v_mul_u32_u24 v13, 18, v12
    v_sub_u32 v13, v11, v13
    v_lshrrev_b32 v14, 3, v12
    v_and_b32 v14, 1, v14
    v_lshlrev_b32 v14, 2, v14
    v_xor_b32 v12, v12, v14
    s_mov_b32 s23, 9216
    v_mul_lo_u32 v12, v12, s23
    v_lshlrev_b32 v14, 4, v13
    v_add_u32 v12, v12, v14

    v_add_u32 v5, s18, v12
    s_mul_i32 s22, s16, 288
    s_add_u32 s22, s22, 128
    v_add_u32 v11, s22, v1
    s_movk_i32 s23, 3641
    v_mul_lo_u32 v12, v11, s23
    v_lshrrev_b32 v12, 16, v12
    v_mul_u32_u24 v13, 18, v12
    v_sub_u32 v13, v11, v13
    v_lshrrev_b32 v14, 3, v12
    v_and_b32 v14, 1, v14
    v_lshlrev_b32 v14, 2, v14
    v_xor_b32 v12, v12, v14
    s_mov_b32 s23, 9216
    v_mul_lo_u32 v12, v12, s23
    v_lshlrev_b32 v14, 4, v13
    v_add_u32 v12, v12, v14

    v_add_u32 v6, s18, v12
    s_mul_i32 s22, s16, 288
    s_add_u32 s22, s22, 192
    v_add_u32 v11, s22, v1
    s_movk_i32 s23, 3641
    v_mul_lo_u32 v12, v11, s23
    v_lshrrev_b32 v12, 16, v12
    v_mul_u32_u24 v13, 18, v12
    v_sub_u32 v13, v11, v13
    v_lshrrev_b32 v14, 3, v12
    v_and_b32 v14, 1, v14
    v_lshlrev_b32 v14, 2, v14
    v_xor_b32 v12, v12, v14
    s_mov_b32 s23, 9216
    v_mul_lo_u32 v12, v12, s23
    v_lshlrev_b32 v14, 4, v13
    v_add_u32 v12, v12, v14

    v_add_u32 v7, s18, v12
    s_mul_i32 s22, s16, 288
    s_add_u32 s22, s22, 256
    v_add_u32 v11, s22, v1
    s_movk_i32 s23, 3641
    v_mul_lo_u32 v12, v11, s23
    v_lshrrev_b32 v12, 16, v12
    v_mul_u32_u24 v13, 18, v12
    v_sub_u32 v13, v11, v13
    v_lshrrev_b32 v14, 3, v12
    v_and_b32 v14, 1, v14
    v_lshlrev_b32 v14, 2, v14
    v_xor_b32 v12, v12, v14
    s_mov_b32 s23, 9216
    v_mul_lo_u32 v12, v12, s23
    v_lshlrev_b32 v14, 4, v13
    v_add_u32 v12, v12, v14

    v_add_u32 v8, s18, v12
    v_lshrrev_b32 v11, 4, v1
    v_and_b32 v12, 15, v1
    v_lshrrev_b32 v13, 2, v12
    v_and_b32 v14, 3, v12
    v_and_b32 v15, 1, v11
    v_lshlrev_b32 v15, 2, v15
    v_lshlrev_b32 v11, 3, v11
    v_add_u32 v11, v11, v13
    v_add_u32 v12, v11, v15
    v_mul_u32_u24 v12, 288, v12
    v_lshlrev_b32 v14, 3, v14
    v_add_u32 v9, v12, v14
    v_xor_b32 v15, 4, v15
    v_add_u32 v12, v11, v15
    v_mul_u32_u24 v12, 288, v12
    v_add_u32 v10, v12, v14

    v_accvgpr_write_b32 a0, 0
    v_accvgpr_write_b32 a1, 0
    v_accvgpr_write_b32 a2, 0
    v_accvgpr_write_b32 a3, 0
    v_accvgpr_write_b32 a4, 0
    v_accvgpr_write_b32 a5, 0
    v_accvgpr_write_b32 a6, 0
    v_accvgpr_write_b32 a7, 0
    v_accvgpr_write_b32 a8, 0
    v_accvgpr_write_b32 a9, 0
    v_accvgpr_write_b32 a10, 0
    v_accvgpr_write_b32 a11, 0
    v_accvgpr_write_b32 a12, 0
    v_accvgpr_write_b32 a13, 0
    v_accvgpr_write_b32 a14, 0
    v_accvgpr_write_b32 a15, 0
    v_accvgpr_write_b32 a16, 0
    v_accvgpr_write_b32 a17, 0
    v_accvgpr_write_b32 a18, 0
    v_accvgpr_write_b32 a19, 0
    v_accvgpr_write_b32 a20, 0
    v_accvgpr_write_b32 a21, 0
    v_accvgpr_write_b32 a22, 0
    v_accvgpr_write_b32 a23, 0
    v_accvgpr_write_b32 a24, 0
    v_accvgpr_write_b32 a25, 0
    v_accvgpr_write_b32 a26, 0
    v_accvgpr_write_b32 a27, 0
    v_accvgpr_write_b32 a28, 0
    v_accvgpr_write_b32 a29, 0
    v_accvgpr_write_b32 a30, 0
    v_accvgpr_write_b32 a31, 0
    v_accvgpr_write_b32 a32, 0
    v_accvgpr_write_b32 a33, 0
    v_accvgpr_write_b32 a34, 0
    v_accvgpr_write_b32 a35, 0
    v_accvgpr_write_b32 a36, 0
    v_accvgpr_write_b32 a37, 0
    v_accvgpr_write_b32 a38, 0
    v_accvgpr_write_b32 a39, 0
    v_accvgpr_write_b32 a40, 0
    v_accvgpr_write_b32 a41, 0
    v_accvgpr_write_b32 a42, 0
    v_accvgpr_write_b32 a43, 0
    v_accvgpr_write_b32 a44, 0
    v_accvgpr_write_b32 a45, 0
    v_accvgpr_write_b32 a46, 0
    v_accvgpr_write_b32 a47, 0
    v_accvgpr_write_b32 a48, 0
    v_accvgpr_write_b32 a49, 0
    v_accvgpr_write_b32 a50, 0
    v_accvgpr_write_b32 a51, 0
    v_accvgpr_write_b32 a52, 0
    v_accvgpr_write_b32 a53, 0
    v_accvgpr_write_b32 a54, 0
    v_accvgpr_write_b32 a55, 0
    v_accvgpr_write_b32 a56, 0
    v_accvgpr_write_b32 a57, 0
    v_accvgpr_write_b32 a58, 0
    v_accvgpr_write_b32 a59, 0
    v_accvgpr_write_b32 a60, 0
    v_accvgpr_write_b32 a61, 0
    v_accvgpr_write_b32 a62, 0
    v_accvgpr_write_b32 a63, 0
    v_accvgpr_write_b32 a64, 0
    v_accvgpr_write_b32 a65, 0
    v_accvgpr_write_b32 a66, 0
    v_accvgpr_write_b32 a67, 0
    v_accvgpr_write_b32 a68, 0
    v_accvgpr_write_b32 a69, 0
    v_accvgpr_write_b32 a70, 0
    v_accvgpr_write_b32 a71, 0
    s_mul_i32 s26, s16, 4608
    s_lshl_b32 s31, s16, 12
    s_mov_b32 s29, 0x7ffffff0
    s_mov_b32 s28, 9
    s_mov_b32 s30, 9

    s_cmp_gt_i32 s28, 0
    s_cselect_b32 s22, s25, s29
    s_cselect_b32 s23, s24, s29
    s_add_u32 m0, s31, 36864
    s_add_u32 s27, s23, 0
    buffer_load_dwordx4 v2, s[4:7], s27 offen lds
    s_add_u32 m0, s31, 37888
    s_add_u32 s27, s23, 9216
    buffer_load_dwordx4 v105, s[4:7], s27 offen lds
    s_add_u32 m0, s31, 38912
    s_add_u32 s27, s23, 18432
    buffer_load_dwordx4 v2, s[4:7], s27 offen lds
    s_add_u32 m0, s31, 39936
    s_add_u32 s27, s23, 27648
    buffer_load_dwordx4 v105, s[4:7], s27 offen lds
    s_add_u32 m0, s26, 0
    s_nop 0
    buffer_load_dwordx4 v4, s[8:11], s22 offen lds
    s_add_u32 m0, s26, 1024
    s_nop 0
    buffer_load_dwordx4 v5, s[8:11], s22 offen lds
    s_add_u32 m0, s26, 2048
    s_nop 0
    buffer_load_dwordx4 v6, s[8:11], s22 offen lds
    s_add_u32 m0, s26, 3072
    s_nop 0
    buffer_load_dwordx4 v7, s[8:11], s22 offen lds
    s_add_u32 m0, s26, 4096
    s_mov_b64 exec, 0xffffffff
    buffer_load_dwordx4 v8, s[8:11], s22 offen lds
    s_mov_b64 exec, -1
    s_add_u32 s25, s25, 589824
    s_add_u32 s24, s24, 128
    s_sub_u32 s28, s28, 1
Lloop_3:
    s_waitcnt vmcnt(0)
    s_barrier
    s_cmp_gt_i32 s28, 0
    s_cselect_b32 s22, s25, s29
    s_cselect_b32 s23, s24, s29
    s_add_u32 m0, s31, 53248
    s_add_u32 s27, s23, 0
    buffer_load_dwordx4 v2, s[4:7], s27 offen lds
    s_add_u32 m0, s31, 54272
    s_add_u32 s27, s23, 9216
    buffer_load_dwordx4 v105, s[4:7], s27 offen lds
    s_add_u32 m0, s31, 55296
    s_add_u32 s27, s23, 18432
    buffer_load_dwordx4 v2, s[4:7], s27 offen lds
    s_add_u32 m0, s31, 56320
    s_add_u32 s27, s23, 27648
    buffer_load_dwordx4 v105, s[4:7], s27 offen lds
    s_add_u32 m0, s26, 18432
    s_nop 0
    buffer_load_dwordx4 v4, s[8:11], s22 offen lds
    s_add_u32 m0, s26, 19456
    s_nop 0
    buffer_load_dwordx4 v5, s[8:11], s22 offen lds
    s_add_u32 m0, s26, 20480
    s_nop 0
    buffer_load_dwordx4 v6, s[8:11], s22 offen lds
    s_add_u32 m0, s26, 21504
    s_nop 0
    buffer_load_dwordx4 v7, s[8:11], s22 offen lds
    s_add_u32 m0, s26, 22528
    s_mov_b64 exec, 0xffffffff
    buffer_load_dwordx4 v8, s[8:11], s22 offen lds
    s_mov_b64 exec, -1
    s_add_u32 s25, s25, 589824
    s_add_u32 s24, s24, 128
    s_sub_u32 s28, s28, 1
    ds_read_b128 v[16:19], v3 offset:0
    ds_read_b128 v[20:23], v104 offset:0
    ds_read_b128 v[24:27], v3 offset:2048
    ds_read_b128 v[28:31], v104 offset:2048
    ds_read_b64_tr_b16 v[80:81], v9 offset:0
    ds_read_b64_tr_b16 v[82:83], v10 offset:0
    ds_read_b64_tr_b16 v[84:85], v9 offset:32
    ds_read_b64_tr_b16 v[86:87], v10 offset:32
    ds_read_b64_tr_b16 v[88:89], v9 offset:64
    ds_read_b64_tr_b16 v[90:91], v10 offset:64
    ds_read_b64_tr_b16 v[92:93], v9 offset:96
    ds_read_b64_tr_b16 v[94:95], v10 offset:96
    ds_read_b64_tr_b16 v[96:97], v9 offset:128
    ds_read_b64_tr_b16 v[98:99], v10 offset:128
    s_waitcnt lgkmcnt(8)
    v_mfma_f32_16x16x32_bf16 a[0:3], v[80:83], v[16:19], a[0:3]
    v_mfma_f32_16x16x32_bf16 a[36:39], v[80:83], v[24:27], a[36:39]
    ds_read_b64_tr_b16 v[100:101], v9 offset:160
    ds_read_b64_tr_b16 v[102:103], v10 offset:160
    s_waitcnt lgkmcnt(8)
    v_mfma_f32_16x16x32_bf16 a[4:7], v[84:87], v[16:19], a[4:7]
    v_mfma_f32_16x16x32_bf16 a[40:43], v[84:87], v[24:27], a[40:43]
    ds_read_b64_tr_b16 v[80:81], v9 offset:192
    ds_read_b64_tr_b16 v[82:83], v10 offset:192
    s_waitcnt lgkmcnt(8)
    v_mfma_f32_16x16x32_bf16 a[8:11], v[88:91], v[16:19], a[8:11]
    v_mfma_f32_16x16x32_bf16 a[44:47], v[88:91], v[24:27], a[44:47]
    ds_read_b64_tr_b16 v[84:85], v9 offset:224
    ds_read_b64_tr_b16 v[86:87], v10 offset:224
    s_waitcnt lgkmcnt(8)
    v_mfma_f32_16x16x32_bf16 a[12:15], v[92:95], v[16:19], a[12:15]
    v_mfma_f32_16x16x32_bf16 a[48:51], v[92:95], v[24:27], a[48:51]
    ds_read_b64_tr_b16 v[88:89], v9 offset:256
    ds_read_b64_tr_b16 v[90:91], v10 offset:256
    s_waitcnt lgkmcnt(8)
    v_mfma_f32_16x16x32_bf16 a[16:19], v[96:99], v[16:19], a[16:19]
    v_mfma_f32_16x16x32_bf16 a[52:55], v[96:99], v[24:27], a[52:55]
    ds_read_b64_tr_b16 v[92:93], v9 offset:9216
    ds_read_b64_tr_b16 v[94:95], v10 offset:9216
    s_waitcnt lgkmcnt(8)
    v_mfma_f32_16x16x32_bf16 a[20:23], v[100:103], v[16:19], a[20:23]
    v_mfma_f32_16x16x32_bf16 a[56:59], v[100:103], v[24:27], a[56:59]
    ds_read_b64_tr_b16 v[96:97], v9 offset:9248
    ds_read_b64_tr_b16 v[98:99], v10 offset:9248
    s_waitcnt lgkmcnt(8)
    v_mfma_f32_16x16x32_bf16 a[24:27], v[80:83], v[16:19], a[24:27]
    v_mfma_f32_16x16x32_bf16 a[60:63], v[80:83], v[24:27], a[60:63]
    ds_read_b64_tr_b16 v[100:101], v9 offset:9280
    ds_read_b64_tr_b16 v[102:103], v10 offset:9280
    s_waitcnt lgkmcnt(8)
    v_mfma_f32_16x16x32_bf16 a[28:31], v[84:87], v[16:19], a[28:31]
    v_mfma_f32_16x16x32_bf16 a[64:67], v[84:87], v[24:27], a[64:67]
    ds_read_b64_tr_b16 v[80:81], v9 offset:9312
    ds_read_b64_tr_b16 v[82:83], v10 offset:9312
    s_waitcnt lgkmcnt(8)
    v_mfma_f32_16x16x32_bf16 a[32:35], v[88:91], v[16:19], a[32:35]
    v_mfma_f32_16x16x32_bf16 a[68:71], v[88:91], v[24:27], a[68:71]
    ds_read_b64_tr_b16 v[84:85], v9 offset:9344
    ds_read_b64_tr_b16 v[86:87], v10 offset:9344
    s_waitcnt lgkmcnt(8)
    v_mfma_f32_16x16x32_bf16 a[0:3], v[92:95], v[20:23], a[0:3]
    v_mfma_f32_16x16x32_bf16 a[36:39], v[92:95], v[28:31], a[36:39]
    ds_read_b64_tr_b16 v[88:89], v9 offset:9376
    ds_read_b64_tr_b16 v[90:91], v10 offset:9376
    s_waitcnt lgkmcnt(8)
    v_mfma_f32_16x16x32_bf16 a[4:7], v[96:99], v[20:23], a[4:7]
    v_mfma_f32_16x16x32_bf16 a[40:43], v[96:99], v[28:31], a[40:43]
    ds_read_b64_tr_b16 v[92:93], v9 offset:9408
    ds_read_b64_tr_b16 v[94:95], v10 offset:9408
    s_waitcnt lgkmcnt(8)
    v_mfma_f32_16x16x32_bf16 a[8:11], v[100:103], v[20:23], a[8:11]
    v_mfma_f32_16x16x32_bf16 a[44:47], v[100:103], v[28:31], a[44:47]
    ds_read_b64_tr_b16 v[96:97], v9 offset:9440
    ds_read_b64_tr_b16 v[98:99], v10 offset:9440
    s_waitcnt lgkmcnt(8)
    v_mfma_f32_16x16x32_bf16 a[12:15], v[80:83], v[20:23], a[12:15]
    v_mfma_f32_16x16x32_bf16 a[48:51], v[80:83], v[28:31], a[48:51]
    ds_read_b64_tr_b16 v[100:101], v9 offset:9472
    ds_read_b64_tr_b16 v[102:103], v10 offset:9472
    s_waitcnt lgkmcnt(8)
    v_mfma_f32_16x16x32_bf16 a[16:19], v[84:87], v[20:23], a[16:19]
    v_mfma_f32_16x16x32_bf16 a[52:55], v[84:87], v[28:31], a[52:55]
    s_waitcnt lgkmcnt(6)
    v_mfma_f32_16x16x32_bf16 a[20:23], v[88:91], v[20:23], a[20:23]
    v_mfma_f32_16x16x32_bf16 a[56:59], v[88:91], v[28:31], a[56:59]
    s_waitcnt lgkmcnt(4)
    v_mfma_f32_16x16x32_bf16 a[24:27], v[92:95], v[20:23], a[24:27]
    v_mfma_f32_16x16x32_bf16 a[60:63], v[92:95], v[28:31], a[60:63]
    s_waitcnt lgkmcnt(2)
    v_mfma_f32_16x16x32_bf16 a[28:31], v[96:99], v[20:23], a[28:31]
    v_mfma_f32_16x16x32_bf16 a[64:67], v[96:99], v[28:31], a[64:67]
    s_waitcnt lgkmcnt(0)
    v_mfma_f32_16x16x32_bf16 a[32:35], v[100:103], v[20:23], a[32:35]
    v_mfma_f32_16x16x32_bf16 a[68:71], v[100:103], v[28:31], a[68:71]
    s_sub_u32 s30, s30, 1
    s_cmp_eq_u32 s30, 0
    s_cbranch_scc1 Lend_4
    s_waitcnt vmcnt(0)
    s_barrier
    s_cmp_gt_i32 s28, 0
    s_cselect_b32 s22, s25, s29
    s_cselect_b32 s23, s24, s29
    s_add_u32 m0, s31, 36864
    s_add_u32 s27, s23, 0
    buffer_load_dwordx4 v2, s[4:7], s27 offen lds
    s_add_u32 m0, s31, 37888
    s_add_u32 s27, s23, 9216
    buffer_load_dwordx4 v105, s[4:7], s27 offen lds
    s_add_u32 m0, s31, 38912
    s_add_u32 s27, s23, 18432
    buffer_load_dwordx4 v2, s[4:7], s27 offen lds
    s_add_u32 m0, s31, 39936
    s_add_u32 s27, s23, 27648
    buffer_load_dwordx4 v105, s[4:7], s27 offen lds
    s_add_u32 m0, s26, 0
    s_nop 0
    buffer_load_dwordx4 v4, s[8:11], s22 offen lds
    s_add_u32 m0, s26, 1024
    s_nop 0
    buffer_load_dwordx4 v5, s[8:11], s22 offen lds
    s_add_u32 m0, s26, 2048
    s_nop 0
    buffer_load_dwordx4 v6, s[8:11], s22 offen lds
    s_add_u32 m0, s26, 3072
    s_nop 0
    buffer_load_dwordx4 v7, s[8:11], s22 offen lds
    s_add_u32 m0, s26, 4096
    s_mov_b64 exec, 0xffffffff
    buffer_load_dwordx4 v8, s[8:11], s22 offen lds
    s_mov_b64 exec, -1
    s_add_u32 s25, s25, 589824
    s_add_u32 s24, s24, 128
    s_sub_u32 s28, s28, 1
    ds_read_b128 v[16:19], v3 offset:16384
    ds_read_b128 v[20:23], v104 offset:16384
    ds_read_b128 v[24:27], v3 offset:18432
    ds_read_b128 v[28:31], v104 offset:18432
    ds_read_b64_tr_b16 v[80:81], v9 offset:18432
    ds_read_b64_tr_b16 v[82:83], v10 offset:18432
    ds_read_b64_tr_b16 v[84:85], v9 offset:18464
    ds_read_b64_tr_b16 v[86:87], v10 offset:18464
    ds_read_b64_tr_b16 v[88:89], v9 offset:18496
    ds_read_b64_tr_b16 v[90:91], v10 offset:18496
    ds_read_b64_tr_b16 v[92:93], v9 offset:18528
    ds_read_b64_tr_b16 v[94:95], v10 offset:18528
    ds_read_b64_tr_b16 v[96:97], v9 offset:18560
    ds_read_b64_tr_b16 v[98:99], v10 offset:18560
    s_waitcnt lgkmcnt(8)
    v_mfma_f32_16x16x32_bf16 a[0:3], v[80:83], v[16:19], a[0:3]
    v_mfma_f32_16x16x32_bf16 a[36:39], v[80:83], v[24:27], a[36:39]
    ds_read_b64_tr_b16 v[100:101], v9 offset:18592
    ds_read_b64_tr_b16 v[102:103], v10 offset:18592
    s_waitcnt lgkmcnt(8)
    v_mfma_f32_16x16x32_bf16 a[4:7], v[84:87], v[16:19], a[4:7]
    v_mfma_f32_16x16x32_bf16 a[40:43], v[84:87], v[24:27], a[40:43]
    ds_read_b64_tr_b16 v[80:81], v9 offset:18624
    ds_read_b64_tr_b16 v[82:83], v10 offset:18624
    s_waitcnt lgkmcnt(8)
    v_mfma_f32_16x16x32_bf16 a[8:11], v[88:91], v[16:19], a[8:11]
    v_mfma_f32_16x16x32_bf16 a[44:47], v[88:91], v[24:27], a[44:47]
    ds_read_b64_tr_b16 v[84:85], v9 offset:18656
    ds_read_b64_tr_b16 v[86:87], v10 offset:18656
    s_waitcnt lgkmcnt(8)
    v_mfma_f32_16x16x32_bf16 a[12:15], v[92:95], v[16:19], a[12:15]
    v_mfma_f32_16x16x32_bf16 a[48:51], v[92:95], v[24:27], a[48:51]
    ds_read_b64_tr_b16 v[88:89], v9 offset:18688
    ds_read_b64_tr_b16 v[90:91], v10 offset:18688
    s_waitcnt lgkmcnt(8)
    v_mfma_f32_16x16x32_bf16 a[16:19], v[96:99], v[16:19], a[16:19]
    v_mfma_f32_16x16x32_bf16 a[52:55], v[96:99], v[24:27], a[52:55]
    ds_read_b64_tr_b16 v[92:93], v9 offset:27648
    ds_read_b64_tr_b16 v[94:95], v10 offset:27648
    s_waitcnt lgkmcnt(8)
    v_mfma_f32_16x16x32_bf16 a[20:23], v[100:103], v[16:19], a[20:23]
    v_mfma_f32_16x16x32_bf16 a[56:59], v[100:103], v[24:27], a[56:59]
    ds_read_b64_tr_b16 v[96:97], v9 offset:27680
    ds_read_b64_tr_b16 v[98:99], v10 offset:27680
    s_waitcnt lgkmcnt(8)
    v_mfma_f32_16x16x32_bf16 a[24:27], v[80:83], v[16:19], a[24:27]
    v_mfma_f32_16x16x32_bf16 a[60:63], v[80:83], v[24:27], a[60:63]
    ds_read_b64_tr_b16 v[100:101], v9 offset:27712
    ds_read_b64_tr_b16 v[102:103], v10 offset:27712
    s_waitcnt lgkmcnt(8)
    v_mfma_f32_16x16x32_bf16 a[28:31], v[84:87], v[16:19], a[28:31]
    v_mfma_f32_16x16x32_bf16 a[64:67], v[84:87], v[24:27], a[64:67]
    ds_read_b64_tr_b16 v[80:81], v9 offset:27744
    ds_read_b64_tr_b16 v[82:83], v10 offset:27744
    s_waitcnt lgkmcnt(8)
    v_mfma_f32_16x16x32_bf16 a[32:35], v[88:91], v[16:19], a[32:35]
    v_mfma_f32_16x16x32_bf16 a[68:71], v[88:91], v[24:27], a[68:71]
    ds_read_b64_tr_b16 v[84:85], v9 offset:27776
    ds_read_b64_tr_b16 v[86:87], v10 offset:27776
    s_waitcnt lgkmcnt(8)
    v_mfma_f32_16x16x32_bf16 a[0:3], v[92:95], v[20:23], a[0:3]
    v_mfma_f32_16x16x32_bf16 a[36:39], v[92:95], v[28:31], a[36:39]
    ds_read_b64_tr_b16 v[88:89], v9 offset:27808
    ds_read_b64_tr_b16 v[90:91], v10 offset:27808
    s_waitcnt lgkmcnt(8)
    v_mfma_f32_16x16x32_bf16 a[4:7], v[96:99], v[20:23], a[4:7]
    v_mfma_f32_16x16x32_bf16 a[40:43], v[96:99], v[28:31], a[40:43]
    ds_read_b64_tr_b16 v[92:93], v9 offset:27840
    ds_read_b64_tr_b16 v[94:95], v10 offset:27840
    s_waitcnt lgkmcnt(8)
    v_mfma_f32_16x16x32_bf16 a[8:11], v[100:103], v[20:23], a[8:11]
    v_mfma_f32_16x16x32_bf16 a[44:47], v[100:103], v[28:31], a[44:47]
    ds_read_b64_tr_b16 v[96:97], v9 offset:27872
    ds_read_b64_tr_b16 v[98:99], v10 offset:27872
    s_waitcnt lgkmcnt(8)
    v_mfma_f32_16x16x32_bf16 a[12:15], v[80:83], v[20:23], a[12:15]
    v_mfma_f32_16x16x32_bf16 a[48:51], v[80:83], v[28:31], a[48:51]
    ds_read_b64_tr_b16 v[100:101], v9 offset:27904
    ds_read_b64_tr_b16 v[102:103], v10 offset:27904
    s_waitcnt lgkmcnt(8)
    v_mfma_f32_16x16x32_bf16 a[16:19], v[84:87], v[20:23], a[16:19]
    v_mfma_f32_16x16x32_bf16 a[52:55], v[84:87], v[28:31], a[52:55]
    s_waitcnt lgkmcnt(6)
    v_mfma_f32_16x16x32_bf16 a[20:23], v[88:91], v[20:23], a[20:23]
    v_mfma_f32_16x16x32_bf16 a[56:59], v[88:91], v[28:31], a[56:59]
    s_waitcnt lgkmcnt(4)
    v_mfma_f32_16x16x32_bf16 a[24:27], v[92:95], v[20:23], a[24:27]
    v_mfma_f32_16x16x32_bf16 a[60:63], v[92:95], v[28:31], a[60:63]
    s_waitcnt lgkmcnt(2)
    v_mfma_f32_16x16x32_bf16 a[28:31], v[96:99], v[20:23], a[28:31]
    v_mfma_f32_16x16x32_bf16 a[64:67], v[96:99], v[28:31], a[64:67]
    s_waitcnt lgkmcnt(0)
    v_mfma_f32_16x16x32_bf16 a[32:35], v[100:103], v[20:23], a[32:35]
    v_mfma_f32_16x16x32_bf16 a[68:71], v[100:103], v[28:31], a[68:71]
    s_sub_u32 s30, s30, 1
    s_cmp_eq_u32 s30, 0
    s_cbranch_scc0 Lloop_3
Lend_4:
    s_waitcnt vmcnt(0)
    s_nop 7
    s_nop 7
    v_and_b32 v11, 15, v1
    s_lshl_b32 s22, s16, 5
    s_add_u32 s22, s22, s17
    v_add_u32 v11, s22, v11
    v_mul_lo_u32 v12, v11, s33
    v_lshrrev_b32 v13, 4, v1
    v_lshlrev_b32 v13, 3, v13
    v_add_u32 v12, v12, v13
    v_add_u32 v12, s18, v12
    v_add_u32 v12, s34, v12
    s_lshl_b32 s22, s33, 4
    v_add_u32 v13, s22, v12

    s_nop 1
    v_accvgpr_read_b32 v16, a0
    v_accvgpr_read_b32 v17, a1
    v_accvgpr_read_b32 v18, a2
    v_accvgpr_read_b32 v19, a3

    v_max_f32 v16, 0, v16
    v_max_f32 v17, 0, v17
    v_max_f32 v18, 0, v18
    v_max_f32 v19, 0, v19
    v_cvt_pk_bf16_f32 v20, v16, v17
    v_cvt_pk_bf16_f32 v21, v18, v19
    buffer_store_dwordx2 v[20:21], v12, s[12:15], 0 offen offset:0

    s_nop 1
    v_accvgpr_read_b32 v24, a4
    v_accvgpr_read_b32 v25, a5
    v_accvgpr_read_b32 v26, a6
    v_accvgpr_read_b32 v27, a7

    v_max_f32 v24, 0, v24
    v_max_f32 v25, 0, v25
    v_max_f32 v26, 0, v26
    v_max_f32 v27, 0, v27
    v_cvt_pk_bf16_f32 v28, v24, v25
    v_cvt_pk_bf16_f32 v29, v26, v27
    buffer_store_dwordx2 v[28:29], v12, s[12:15], 0 offen offset:32

    s_nop 1
    v_accvgpr_read_b32 v32, a8
    v_accvgpr_read_b32 v33, a9
    v_accvgpr_read_b32 v34, a10
    v_accvgpr_read_b32 v35, a11

    v_max_f32 v32, 0, v32
    v_max_f32 v33, 0, v33
    v_max_f32 v34, 0, v34
    v_max_f32 v35, 0, v35
    v_cvt_pk_bf16_f32 v36, v32, v33
    v_cvt_pk_bf16_f32 v37, v34, v35
    buffer_store_dwordx2 v[36:37], v12, s[12:15], 0 offen offset:64

    s_nop 1
    v_accvgpr_read_b32 v40, a12
    v_accvgpr_read_b32 v41, a13
    v_accvgpr_read_b32 v42, a14
    v_accvgpr_read_b32 v43, a15

    v_max_f32 v40, 0, v40
    v_max_f32 v41, 0, v41
    v_max_f32 v42, 0, v42
    v_max_f32 v43, 0, v43
    v_cvt_pk_bf16_f32 v44, v40, v41
    v_cvt_pk_bf16_f32 v45, v42, v43
    buffer_store_dwordx2 v[44:45], v12, s[12:15], 0 offen offset:96

    s_nop 1
    v_accvgpr_read_b32 v16, a16
    v_accvgpr_read_b32 v17, a17
    v_accvgpr_read_b32 v18, a18
    v_accvgpr_read_b32 v19, a19

    v_max_f32 v16, 0, v16
    v_max_f32 v17, 0, v17
    v_max_f32 v18, 0, v18
    v_max_f32 v19, 0, v19
    v_cvt_pk_bf16_f32 v20, v16, v17
    v_cvt_pk_bf16_f32 v21, v18, v19
    buffer_store_dwordx2 v[20:21], v12, s[12:15], 0 offen offset:128

    s_nop 1
    v_accvgpr_read_b32 v24, a20
    v_accvgpr_read_b32 v25, a21
    v_accvgpr_read_b32 v26, a22
    v_accvgpr_read_b32 v27, a23

    v_max_f32 v24, 0, v24
    v_max_f32 v25, 0, v25
    v_max_f32 v26, 0, v26
    v_max_f32 v27, 0, v27
    v_cvt_pk_bf16_f32 v28, v24, v25
    v_cvt_pk_bf16_f32 v29, v26, v27
    buffer_store_dwordx2 v[28:29], v12, s[12:15], 0 offen offset:160

    s_nop 1
    v_accvgpr_read_b32 v32, a24
    v_accvgpr_read_b32 v33, a25
    v_accvgpr_read_b32 v34, a26
    v_accvgpr_read_b32 v35, a27

    v_max_f32 v32, 0, v32
    v_max_f32 v33, 0, v33
    v_max_f32 v34, 0, v34
    v_max_f32 v35, 0, v35
    v_cvt_pk_bf16_f32 v36, v32, v33
    v_cvt_pk_bf16_f32 v37, v34, v35
    buffer_store_dwordx2 v[36:37], v12, s[12:15], 0 offen offset:192

    s_nop 1
    v_accvgpr_read_b32 v40, a28
    v_accvgpr_read_b32 v41, a29
    v_accvgpr_read_b32 v42, a30
    v_accvgpr_read_b32 v43, a31

    v_max_f32 v40, 0, v40
    v_max_f32 v41, 0, v41
    v_max_f32 v42, 0, v42
    v_max_f32 v43, 0, v43
    v_cvt_pk_bf16_f32 v44, v40, v41
    v_cvt_pk_bf16_f32 v45, v42, v43
    buffer_store_dwordx2 v[44:45], v12, s[12:15], 0 offen offset:224

    s_nop 1
    v_accvgpr_read_b32 v16, a32
    v_accvgpr_read_b32 v17, a33
    v_accvgpr_read_b32 v18, a34
    v_accvgpr_read_b32 v19, a35

    v_max_f32 v16, 0, v16
    v_max_f32 v17, 0, v17
    v_max_f32 v18, 0, v18
    v_max_f32 v19, 0, v19
    v_cvt_pk_bf16_f32 v20, v16, v17
    v_cvt_pk_bf16_f32 v21, v18, v19
    buffer_store_dwordx2 v[20:21], v12, s[12:15], 0 offen offset:256

    s_nop 1
    v_accvgpr_read_b32 v16, a36
    v_accvgpr_read_b32 v17, a37
    v_accvgpr_read_b32 v18, a38
    v_accvgpr_read_b32 v19, a39

    v_max_f32 v16, 0, v16
    v_max_f32 v17, 0, v17
    v_max_f32 v18, 0, v18
    v_max_f32 v19, 0, v19
    v_cvt_pk_bf16_f32 v20, v16, v17
    v_cvt_pk_bf16_f32 v21, v18, v19
    buffer_store_dwordx2 v[20:21], v13, s[12:15], 0 offen offset:0

    s_nop 1
    v_accvgpr_read_b32 v24, a40
    v_accvgpr_read_b32 v25, a41
    v_accvgpr_read_b32 v26, a42
    v_accvgpr_read_b32 v27, a43

    v_max_f32 v24, 0, v24
    v_max_f32 v25, 0, v25
    v_max_f32 v26, 0, v26
    v_max_f32 v27, 0, v27
    v_cvt_pk_bf16_f32 v28, v24, v25
    v_cvt_pk_bf16_f32 v29, v26, v27
    buffer_store_dwordx2 v[28:29], v13, s[12:15], 0 offen offset:32

    s_nop 1
    v_accvgpr_read_b32 v32, a44
    v_accvgpr_read_b32 v33, a45
    v_accvgpr_read_b32 v34, a46
    v_accvgpr_read_b32 v35, a47

    v_max_f32 v32, 0, v32
    v_max_f32 v33, 0, v33
    v_max_f32 v34, 0, v34
    v_max_f32 v35, 0, v35
    v_cvt_pk_bf16_f32 v36, v32, v33
    v_cvt_pk_bf16_f32 v37, v34, v35
    buffer_store_dwordx2 v[36:37], v13, s[12:15], 0 offen offset:64

    s_nop 1
    v_accvgpr_read_b32 v40, a48
    v_accvgpr_read_b32 v41, a49
    v_accvgpr_read_b32 v42, a50
    v_accvgpr_read_b32 v43, a51

    v_max_f32 v40, 0, v40
    v_max_f32 v41, 0, v41
    v_max_f32 v42, 0, v42
    v_max_f32 v43, 0, v43
    v_cvt_pk_bf16_f32 v44, v40, v41
    v_cvt_pk_bf16_f32 v45, v42, v43
    buffer_store_dwordx2 v[44:45], v13, s[12:15], 0 offen offset:96

    s_nop 1
    v_accvgpr_read_b32 v16, a52
    v_accvgpr_read_b32 v17, a53
    v_accvgpr_read_b32 v18, a54
    v_accvgpr_read_b32 v19, a55

    v_max_f32 v16, 0, v16
    v_max_f32 v17, 0, v17
    v_max_f32 v18, 0, v18
    v_max_f32 v19, 0, v19
    v_cvt_pk_bf16_f32 v20, v16, v17
    v_cvt_pk_bf16_f32 v21, v18, v19
    buffer_store_dwordx2 v[20:21], v13, s[12:15], 0 offen offset:128

    s_nop 1
    v_accvgpr_read_b32 v24, a56
    v_accvgpr_read_b32 v25, a57
    v_accvgpr_read_b32 v26, a58
    v_accvgpr_read_b32 v27, a59

    v_max_f32 v24, 0, v24
    v_max_f32 v25, 0, v25
    v_max_f32 v26, 0, v26
    v_max_f32 v27, 0, v27
    v_cvt_pk_bf16_f32 v28, v24, v25
    v_cvt_pk_bf16_f32 v29, v26, v27
    buffer_store_dwordx2 v[28:29], v13, s[12:15], 0 offen offset:160

    s_nop 1
    v_accvgpr_read_b32 v32, a60
    v_accvgpr_read_b32 v33, a61
    v_accvgpr_read_b32 v34, a62
    v_accvgpr_read_b32 v35, a63

    v_max_f32 v32, 0, v32
    v_max_f32 v33, 0, v33
    v_max_f32 v34, 0, v34
    v_max_f32 v35, 0, v35
    v_cvt_pk_bf16_f32 v36, v32, v33
    v_cvt_pk_bf16_f32 v37, v34, v35
    buffer_store_dwordx2 v[36:37], v13, s[12:15], 0 offen offset:192

    s_nop 1
    v_accvgpr_read_b32 v40, a64
    v_accvgpr_read_b32 v41, a65
    v_accvgpr_read_b32 v42, a66
    v_accvgpr_read_b32 v43, a67

    v_max_f32 v40, 0, v40
    v_max_f32 v41, 0, v41
    v_max_f32 v42, 0, v42
    v_max_f32 v43, 0, v43
    v_cvt_pk_bf16_f32 v44, v40, v41
    v_cvt_pk_bf16_f32 v45, v42, v43
    buffer_store_dwordx2 v[44:45], v13, s[12:15], 0 offen offset:224

    s_nop 1
    v_accvgpr_read_b32 v16, a68
    v_accvgpr_read_b32 v17, a69
    v_accvgpr_read_b32 v18, a70
    v_accvgpr_read_b32 v19, a71

    v_max_f32 v16, 0, v16
    v_max_f32 v17, 0, v17
    v_max_f32 v18, 0, v18
    v_max_f32 v19, 0, v19
    v_cvt_pk_bf16_f32 v20, v16, v17
    v_cvt_pk_bf16_f32 v21, v18, v19
    buffer_store_dwordx2 v[20:21], v13, s[12:15], 0 offen offset:256

k1_done:
    s_endpgm
.globl kkv_kernel
.p2align 8
.type kkv_kernel,@function
kkv_kernel:
    s_load_dwordx2 s[46:47], s[0:1], 72
    s_cmp_ge_u32 s2, 512
    s_cbranch_scc1 kkv_done
    s_waitcnt lgkmcnt(0)

    s_mov_b32 s12, s46
    s_mov_b32 s13, s47
    s_mov_b32 s14, 268435456
    s_mov_b32 s15, 0x00020000
    s_lshr_b32 s4, s2, 4
    s_and_b32 s5, s2, 15
    v_lshrrev_b32 v1, 1, v0
    v_and_b32 v2, 1, v0
    s_lshl_b32 s6, s5, 7
    v_add_u32 v3, s6, v1
    s_movk_i32 s7, 3456
    v_mul_lo_u32 v3, v3, s7
    s_mul_i32 s8, s4, 36
    s_add_u32 s8, s8, 20972672
    v_add_u32 v3, s8, v3
    v_mul_u32_u24 v4, 1152, v2
    v_add_u32 v3, v3, v4

    buffer_load_dwordx4 v[16:19], v3, s[12:15], 0 offen
    buffer_load_dwordx4 v[20:23], v3, s[12:15], 0 offen offset:16
    buffer_load_dword v24, v3, s[12:15], 0 offen offset:32
    v_mul_u32_u24 v5, 144, v1
    v_mul_u32_u24 v6, 72, v2
    v_add_u32 v5, v5, v6
    v_cmp_eq_u32 s[20:21], 0, v2
    s_waitcnt vmcnt(0)

    v_lshlrev_b32 v30, 16, v16
    v_mov_b32 v31, v30
    v_add_f32 v32, 1.0, v31
    v_mul_f32 v33, 0x3fb8aa3b, v31
    v_exp_f32 v33, v33
    v_cmp_lt_f32 vcc, 0, v31
    v_cndmask_b32 v31, v33, v32, vcc
    v_cvt_pk_bf16_f32 v31, v31, v31
    v_lshlrev_b32 v31, 16, v31
    v_add_f32 v31, 0x358637bd, v31
    v_cvt_pk_bf16_f32 v31, v31, v31
    v_lshlrev_b32 v31, 16, v31

    v_cndmask_b32 v30, v30, v31, s[20:21]
    ds_write_b32 v5, v30 offset:0
    v_and_b32 v30, 0xffff0000, v16
    v_mov_b32 v31, v30
    v_add_f32 v32, 1.0, v31
    v_mul_f32 v33, 0x3fb8aa3b, v31
    v_exp_f32 v33, v33
    v_cmp_lt_f32 vcc, 0, v31
    v_cndmask_b32 v31, v33, v32, vcc
    v_cvt_pk_bf16_f32 v31, v31, v31
    v_lshlrev_b32 v31, 16, v31
    v_add_f32 v31, 0x358637bd, v31
    v_cvt_pk_bf16_f32 v31, v31, v31
    v_lshlrev_b32 v31, 16, v31

    v_cndmask_b32 v30, v30, v31, s[20:21]
    ds_write_b32 v5, v30 offset:4
    v_lshlrev_b32 v30, 16, v17
    v_mov_b32 v31, v30
    v_add_f32 v32, 1.0, v31
    v_mul_f32 v33, 0x3fb8aa3b, v31
    v_exp_f32 v33, v33
    v_cmp_lt_f32 vcc, 0, v31
    v_cndmask_b32 v31, v33, v32, vcc
    v_cvt_pk_bf16_f32 v31, v31, v31
    v_lshlrev_b32 v31, 16, v31
    v_add_f32 v31, 0x358637bd, v31
    v_cvt_pk_bf16_f32 v31, v31, v31
    v_lshlrev_b32 v31, 16, v31

    v_cndmask_b32 v30, v30, v31, s[20:21]
    ds_write_b32 v5, v30 offset:8
    v_and_b32 v30, 0xffff0000, v17
    v_mov_b32 v31, v30
    v_add_f32 v32, 1.0, v31
    v_mul_f32 v33, 0x3fb8aa3b, v31
    v_exp_f32 v33, v33
    v_cmp_lt_f32 vcc, 0, v31
    v_cndmask_b32 v31, v33, v32, vcc
    v_cvt_pk_bf16_f32 v31, v31, v31
    v_lshlrev_b32 v31, 16, v31
    v_add_f32 v31, 0x358637bd, v31
    v_cvt_pk_bf16_f32 v31, v31, v31
    v_lshlrev_b32 v31, 16, v31

    v_cndmask_b32 v30, v30, v31, s[20:21]
    ds_write_b32 v5, v30 offset:12
    v_lshlrev_b32 v30, 16, v18
    v_mov_b32 v31, v30
    v_add_f32 v32, 1.0, v31
    v_mul_f32 v33, 0x3fb8aa3b, v31
    v_exp_f32 v33, v33
    v_cmp_lt_f32 vcc, 0, v31
    v_cndmask_b32 v31, v33, v32, vcc
    v_cvt_pk_bf16_f32 v31, v31, v31
    v_lshlrev_b32 v31, 16, v31
    v_add_f32 v31, 0x358637bd, v31
    v_cvt_pk_bf16_f32 v31, v31, v31
    v_lshlrev_b32 v31, 16, v31

    v_cndmask_b32 v30, v30, v31, s[20:21]
    ds_write_b32 v5, v30 offset:16
    v_and_b32 v30, 0xffff0000, v18
    v_mov_b32 v31, v30
    v_add_f32 v32, 1.0, v31
    v_mul_f32 v33, 0x3fb8aa3b, v31
    v_exp_f32 v33, v33
    v_cmp_lt_f32 vcc, 0, v31
    v_cndmask_b32 v31, v33, v32, vcc
    v_cvt_pk_bf16_f32 v31, v31, v31
    v_lshlrev_b32 v31, 16, v31
    v_add_f32 v31, 0x358637bd, v31
    v_cvt_pk_bf16_f32 v31, v31, v31
    v_lshlrev_b32 v31, 16, v31

    v_cndmask_b32 v30, v30, v31, s[20:21]
    ds_write_b32 v5, v30 offset:20
    v_lshlrev_b32 v30, 16, v19
    v_mov_b32 v31, v30
    v_add_f32 v32, 1.0, v31
    v_mul_f32 v33, 0x3fb8aa3b, v31
    v_exp_f32 v33, v33
    v_cmp_lt_f32 vcc, 0, v31
    v_cndmask_b32 v31, v33, v32, vcc
    v_cvt_pk_bf16_f32 v31, v31, v31
    v_lshlrev_b32 v31, 16, v31
    v_add_f32 v31, 0x358637bd, v31
    v_cvt_pk_bf16_f32 v31, v31, v31
    v_lshlrev_b32 v31, 16, v31

    v_cndmask_b32 v30, v30, v31, s[20:21]
    ds_write_b32 v5, v30 offset:24
    v_and_b32 v30, 0xffff0000, v19
    v_mov_b32 v31, v30
    v_add_f32 v32, 1.0, v31
    v_mul_f32 v33, 0x3fb8aa3b, v31
    v_exp_f32 v33, v33
    v_cmp_lt_f32 vcc, 0, v31
    v_cndmask_b32 v31, v33, v32, vcc
    v_cvt_pk_bf16_f32 v31, v31, v31
    v_lshlrev_b32 v31, 16, v31
    v_add_f32 v31, 0x358637bd, v31
    v_cvt_pk_bf16_f32 v31, v31, v31
    v_lshlrev_b32 v31, 16, v31

    v_cndmask_b32 v30, v30, v31, s[20:21]
    ds_write_b32 v5, v30 offset:28
    v_lshlrev_b32 v30, 16, v20
    v_mov_b32 v31, v30
    v_add_f32 v32, 1.0, v31
    v_mul_f32 v33, 0x3fb8aa3b, v31
    v_exp_f32 v33, v33
    v_cmp_lt_f32 vcc, 0, v31
    v_cndmask_b32 v31, v33, v32, vcc
    v_cvt_pk_bf16_f32 v31, v31, v31
    v_lshlrev_b32 v31, 16, v31
    v_add_f32 v31, 0x358637bd, v31
    v_cvt_pk_bf16_f32 v31, v31, v31
    v_lshlrev_b32 v31, 16, v31

    v_cndmask_b32 v30, v30, v31, s[20:21]
    ds_write_b32 v5, v30 offset:32
    v_and_b32 v30, 0xffff0000, v20
    v_mov_b32 v31, v30
    v_add_f32 v32, 1.0, v31
    v_mul_f32 v33, 0x3fb8aa3b, v31
    v_exp_f32 v33, v33
    v_cmp_lt_f32 vcc, 0, v31
    v_cndmask_b32 v31, v33, v32, vcc
    v_cvt_pk_bf16_f32 v31, v31, v31
    v_lshlrev_b32 v31, 16, v31
    v_add_f32 v31, 0x358637bd, v31
    v_cvt_pk_bf16_f32 v31, v31, v31
    v_lshlrev_b32 v31, 16, v31

    v_cndmask_b32 v30, v30, v31, s[20:21]
    ds_write_b32 v5, v30 offset:36
    v_lshlrev_b32 v30, 16, v21
    v_mov_b32 v31, v30
    v_add_f32 v32, 1.0, v31
    v_mul_f32 v33, 0x3fb8aa3b, v31
    v_exp_f32 v33, v33
    v_cmp_lt_f32 vcc, 0, v31
    v_cndmask_b32 v31, v33, v32, vcc
    v_cvt_pk_bf16_f32 v31, v31, v31
    v_lshlrev_b32 v31, 16, v31
    v_add_f32 v31, 0x358637bd, v31
    v_cvt_pk_bf16_f32 v31, v31, v31
    v_lshlrev_b32 v31, 16, v31

    v_cndmask_b32 v30, v30, v31, s[20:21]
    ds_write_b32 v5, v30 offset:40
    v_and_b32 v30, 0xffff0000, v21
    v_mov_b32 v31, v30
    v_add_f32 v32, 1.0, v31
    v_mul_f32 v33, 0x3fb8aa3b, v31
    v_exp_f32 v33, v33
    v_cmp_lt_f32 vcc, 0, v31
    v_cndmask_b32 v31, v33, v32, vcc
    v_cvt_pk_bf16_f32 v31, v31, v31
    v_lshlrev_b32 v31, 16, v31
    v_add_f32 v31, 0x358637bd, v31
    v_cvt_pk_bf16_f32 v31, v31, v31
    v_lshlrev_b32 v31, 16, v31

    v_cndmask_b32 v30, v30, v31, s[20:21]
    ds_write_b32 v5, v30 offset:44
    v_lshlrev_b32 v30, 16, v22
    v_mov_b32 v31, v30
    v_add_f32 v32, 1.0, v31
    v_mul_f32 v33, 0x3fb8aa3b, v31
    v_exp_f32 v33, v33
    v_cmp_lt_f32 vcc, 0, v31
    v_cndmask_b32 v31, v33, v32, vcc
    v_cvt_pk_bf16_f32 v31, v31, v31
    v_lshlrev_b32 v31, 16, v31
    v_add_f32 v31, 0x358637bd, v31
    v_cvt_pk_bf16_f32 v31, v31, v31
    v_lshlrev_b32 v31, 16, v31

    v_cndmask_b32 v30, v30, v31, s[20:21]
    ds_write_b32 v5, v30 offset:48
    v_and_b32 v30, 0xffff0000, v22
    v_mov_b32 v31, v30
    v_add_f32 v32, 1.0, v31
    v_mul_f32 v33, 0x3fb8aa3b, v31
    v_exp_f32 v33, v33
    v_cmp_lt_f32 vcc, 0, v31
    v_cndmask_b32 v31, v33, v32, vcc
    v_cvt_pk_bf16_f32 v31, v31, v31
    v_lshlrev_b32 v31, 16, v31
    v_add_f32 v31, 0x358637bd, v31
    v_cvt_pk_bf16_f32 v31, v31, v31
    v_lshlrev_b32 v31, 16, v31

    v_cndmask_b32 v30, v30, v31, s[20:21]
    ds_write_b32 v5, v30 offset:52
    v_lshlrev_b32 v30, 16, v23
    v_mov_b32 v31, v30
    v_add_f32 v32, 1.0, v31
    v_mul_f32 v33, 0x3fb8aa3b, v31
    v_exp_f32 v33, v33
    v_cmp_lt_f32 vcc, 0, v31
    v_cndmask_b32 v31, v33, v32, vcc
    v_cvt_pk_bf16_f32 v31, v31, v31
    v_lshlrev_b32 v31, 16, v31
    v_add_f32 v31, 0x358637bd, v31
    v_cvt_pk_bf16_f32 v31, v31, v31
    v_lshlrev_b32 v31, 16, v31

    v_cndmask_b32 v30, v30, v31, s[20:21]
    ds_write_b32 v5, v30 offset:56
    v_and_b32 v30, 0xffff0000, v23
    v_mov_b32 v31, v30
    v_add_f32 v32, 1.0, v31
    v_mul_f32 v33, 0x3fb8aa3b, v31
    v_exp_f32 v33, v33
    v_cmp_lt_f32 vcc, 0, v31
    v_cndmask_b32 v31, v33, v32, vcc
    v_cvt_pk_bf16_f32 v31, v31, v31
    v_lshlrev_b32 v31, 16, v31
    v_add_f32 v31, 0x358637bd, v31
    v_cvt_pk_bf16_f32 v31, v31, v31
    v_lshlrev_b32 v31, 16, v31

    v_cndmask_b32 v30, v30, v31, s[20:21]
    ds_write_b32 v5, v30 offset:60
    v_lshlrev_b32 v30, 16, v24
    v_mov_b32 v31, v30
    v_add_f32 v32, 1.0, v31
    v_mul_f32 v33, 0x3fb8aa3b, v31
    v_exp_f32 v33, v33
    v_cmp_lt_f32 vcc, 0, v31
    v_cndmask_b32 v31, v33, v32, vcc
    v_cvt_pk_bf16_f32 v31, v31, v31
    v_lshlrev_b32 v31, 16, v31
    v_add_f32 v31, 0x358637bd, v31
    v_cvt_pk_bf16_f32 v31, v31, v31
    v_lshlrev_b32 v31, 16, v31

    v_cndmask_b32 v30, v30, v31, s[20:21]
    ds_write_b32 v5, v30 offset:64
    v_and_b32 v30, 0xffff0000, v24
    v_mov_b32 v31, v30
    v_add_f32 v32, 1.0, v31
    v_mul_f32 v33, 0x3fb8aa3b, v31
    v_exp_f32 v33, v33
    v_cmp_lt_f32 vcc, 0, v31
    v_cndmask_b32 v31, v33, v32, vcc
    v_cvt_pk_bf16_f32 v31, v31, v31
    v_lshlrev_b32 v31, 16, v31
    v_add_f32 v31, 0x358637bd, v31
    v_cvt_pk_bf16_f32 v31, v31, v31
    v_lshlrev_b32 v31, 16, v31

    v_cndmask_b32 v30, v30, v31, s[20:21]
    ds_write_b32 v5, v30 offset:68
    s_waitcnt lgkmcnt(0)
    s_barrier
    v_add_u32 v7, 0, v0
    s_movk_i32 s7, 3641
    v_mul_lo_u32 v8, v7, s7
    v_lshrrev_b32 v8, 16, v8
    v_mul_u32_u24 v9, 18, v8
    v_sub_u32 v9, v7, v9
    v_cmp_gt_u32 vcc, 324, v7
    v_cndmask_b32 v8, v9, v8, vcc
    v_lshlrev_b32 v8, 2, v8
    v_lshlrev_b32 v9, 2, v9
    v_add_u32 v9, 72, v9
    v_mov_b32 v10, 0
    s_mov_b32 s10, 0

kvL_5:
    ds_read_b32 v40, v8 offset:0
    ds_read_b32 v48, v9 offset:0
    ds_read_b32 v41, v8 offset:144
    ds_read_b32 v49, v9 offset:144
    ds_read_b32 v42, v8 offset:288
    ds_read_b32 v50, v9 offset:288
    ds_read_b32 v43, v8 offset:432
    ds_read_b32 v51, v9 offset:432
    ds_read_b32 v44, v8 offset:576
    ds_read_b32 v52, v9 offset:576
    ds_read_b32 v45, v8 offset:720
    ds_read_b32 v53, v9 offset:720
    ds_read_b32 v46, v8 offset:864
    ds_read_b32 v54, v9 offset:864
    ds_read_b32 v47, v8 offset:1008
    ds_read_b32 v55, v9 offset:1008
    v_add_u32 v8, 1152, v8
    v_add_u32 v9, 1152, v9
    s_waitcnt lgkmcnt(0)
    v_cndmask_b32 v48, 1.0, v48, vcc
    v_fmac_f32 v10, v40, v48
    v_cndmask_b32 v49, 1.0, v49, vcc
    v_fmac_f32 v10, v41, v49
    v_cndmask_b32 v50, 1.0, v50, vcc
    v_fmac_f32 v10, v42, v50
    v_cndmask_b32 v51, 1.0, v51, vcc
    v_fmac_f32 v10, v43, v51
    v_cndmask_b32 v52, 1.0, v52, vcc
    v_fmac_f32 v10, v44, v52
    v_cndmask_b32 v53, 1.0, v53, vcc
    v_fmac_f32 v10, v45, v53
    v_cndmask_b32 v54, 1.0, v54, vcc
    v_fmac_f32 v10, v46, v54
    v_cndmask_b32 v55, 1.0, v55, vcc
    v_fmac_f32 v10, v47, v55
    s_add_u32 s10, s10, 8
    s_cmp_lt_u32 s10, 128
    s_cbranch_scc1 kvL_5
    s_mul_i32 s11, s2, 1368
    s_add_u32 s11, s11, 28573696
    v_lshlrev_b32 v13, 2, v7
    v_add_u32 v13, s11, v13
    v_cmp_gt_u32 vcc, 342, v7
    s_and_saveexec_b64 s[24:25], vcc
    buffer_store_dword v10, v13, s[12:15], 0 offen
    s_mov_b64 exec, s[24:25]

    v_add_u32 v7, 256, v0
    s_movk_i32 s7, 3641
    v_mul_lo_u32 v8, v7, s7
    v_lshrrev_b32 v8, 16, v8
    v_mul_u32_u24 v9, 18, v8
    v_sub_u32 v9, v7, v9
    v_cmp_gt_u32 vcc, 324, v7
    v_cndmask_b32 v8, v9, v8, vcc
    v_lshlrev_b32 v8, 2, v8
    v_lshlrev_b32 v9, 2, v9
    v_add_u32 v9, 72, v9
    v_mov_b32 v10, 0
    s_mov_b32 s10, 0

kvL_6:
    ds_read_b32 v40, v8 offset:0
    ds_read_b32 v48, v9 offset:0
    ds_read_b32 v41, v8 offset:144
    ds_read_b32 v49, v9 offset:144
    ds_read_b32 v42, v8 offset:288
    ds_read_b32 v50, v9 offset:288
    ds_read_b32 v43, v8 offset:432
    ds_read_b32 v51, v9 offset:432
    ds_read_b32 v44, v8 offset:576
    ds_read_b32 v52, v9 offset:576
    ds_read_b32 v45, v8 offset:720
    ds_read_b32 v53, v9 offset:720
    ds_read_b32 v46, v8 offset:864
    ds_read_b32 v54, v9 offset:864
    ds_read_b32 v47, v8 offset:1008
    ds_read_b32 v55, v9 offset:1008
    v_add_u32 v8, 1152, v8
    v_add_u32 v9, 1152, v9
    s_waitcnt lgkmcnt(0)
    v_cndmask_b32 v48, 1.0, v48, vcc
    v_fmac_f32 v10, v40, v48
    v_cndmask_b32 v49, 1.0, v49, vcc
    v_fmac_f32 v10, v41, v49
    v_cndmask_b32 v50, 1.0, v50, vcc
    v_fmac_f32 v10, v42, v50
    v_cndmask_b32 v51, 1.0, v51, vcc
    v_fmac_f32 v10, v43, v51
    v_cndmask_b32 v52, 1.0, v52, vcc
    v_fmac_f32 v10, v44, v52
    v_cndmask_b32 v53, 1.0, v53, vcc
    v_fmac_f32 v10, v45, v53
    v_cndmask_b32 v54, 1.0, v54, vcc
    v_fmac_f32 v10, v46, v54
    v_cndmask_b32 v55, 1.0, v55, vcc
    v_fmac_f32 v10, v47, v55
    s_add_u32 s10, s10, 8
    s_cmp_lt_u32 s10, 128
    s_cbranch_scc1 kvL_6
    s_mul_i32 s11, s2, 1368
    s_add_u32 s11, s11, 28573696
    v_lshlrev_b32 v13, 2, v7
    v_add_u32 v13, s11, v13
    v_cmp_gt_u32 vcc, 342, v7
    s_and_saveexec_b64 s[24:25], vcc
    buffer_store_dword v10, v13, s[12:15], 0 offen
    s_mov_b64 exec, s[24:25]

kkv_done:
    s_endpgm
.globl ko_kernel
.p2align 8
.type ko_kernel,@function
ko_kernel:
    s_load_dwordx2 s[46:47], s[0:1], 72
    s_cmp_ge_u32 s2, 256
    s_cbranch_scc1 ko_done
    v_lshrrev_b32 v2, 6, v0
    v_and_b32 v1, 63, v0
    s_nop 0
    v_readfirstlane_b32 s16, v2
    s_and_b32 s4, s2, 7
    s_lshl_b32 s4, s4, 2
    s_add_u32 s4, s4, s16
    s_lshr_b32 s5, s2, 3
    s_lshl_b32 s5, s5, 6
    s_waitcnt lgkmcnt(0)

    s_mov_b32 s12, s46
    s_mov_b32 s13, s47
    s_mov_b32 s14, 268435456
    s_mov_b32 s15, 0x00020000
    v_add_u32 v3, s5, v1
    s_movk_i32 s7, 3456
    v_mul_lo_u32 v3, v3, s7
    s_mul_i32 s8, s4, 36
    s_add_u32 s8, s8, 20971520
    v_add_u32 v3, s8, v3

    buffer_load_dwordx4 v[16:19], v3, s[12:15], 0 offen
    buffer_load_dwordx4 v[20:23], v3, s[12:15], 0 offen offset:16
    buffer_load_dword v24, v3, s[12:15], 0 offen offset:32
    s_mul_i32 s6, s4, 21888
    s_add_u32 s6, s6, 28573696
    v_lshlrev_b32 v4, 2, v1
    v_add_u32 v5, s6, v4
    s_mul_i32 s9, s16, 1536
    v_add_u32 v6, s9, v4

    s_movk_i32 s9, 0
    buffer_load_dword v64, v5, s[12:15], s9 offen offset:0
    buffer_load_dword v65, v5, s[12:15], s9 offen offset:256
    buffer_load_dword v66, v5, s[12:15], s9 offen offset:512
    buffer_load_dword v67, v5, s[12:15], s9 offen offset:768
    buffer_load_dword v68, v5, s[12:15], s9 offen offset:1024
    buffer_load_dword v69, v5, s[12:15], s9 offen offset:1280
    s_movk_i32 s9, 1368
    buffer_load_dword v70, v5, s[12:15], s9 offen offset:0
    buffer_load_dword v71, v5, s[12:15], s9 offen offset:256
    buffer_load_dword v72, v5, s[12:15], s9 offen offset:512
    buffer_load_dword v73, v5, s[12:15], s9 offen offset:768
    buffer_load_dword v74, v5, s[12:15], s9 offen offset:1024
    buffer_load_dword v75, v5, s[12:15], s9 offen offset:1280
    s_movk_i32 s9, 2736
    buffer_load_dword v76, v5, s[12:15], s9 offen offset:0
    buffer_load_dword v77, v5, s[12:15], s9 offen offset:256
    buffer_load_dword v78, v5, s[12:15], s9 offen offset:512
    buffer_load_dword v79, v5, s[12:15], s9 offen offset:768
    buffer_load_dword v80, v5, s[12:15], s9 offen offset:1024
    buffer_load_dword v81, v5, s[12:15], s9 offen offset:1280
    s_movk_i32 s9, 4104
    buffer_load_dword v82, v5, s[12:15], s9 offen offset:0
    buffer_load_dword v83, v5, s[12:15], s9 offen offset:256
    buffer_load_dword v84, v5, s[12:15], s9 offen offset:512
    buffer_load_dword v85, v5, s[12:15], s9 offen offset:768
    buffer_load_dword v86, v5, s[12:15], s9 offen offset:1024
    buffer_load_dword v87, v5, s[12:15], s9 offen offset:1280
    s_movk_i32 s9, 5472
    buffer_load_dword v88, v5, s[12:15], s9 offen offset:0
    buffer_load_dword v89, v5, s[12:15], s9 offen offset:256
    buffer_load_dword v90, v5, s[12:15], s9 offen offset:512
    buffer_load_dword v91, v5, s[12:15], s9 offen offset:768
    buffer_load_dword v92, v5, s[12:15], s9 offen offset:1024
    buffer_load_dword v93, v5, s[12:15], s9 offen offset:1280
    s_movk_i32 s9, 6840
    buffer_load_dword v94, v5, s[12:15], s9 offen offset:0
    buffer_load_dword v95, v5, s[12:15], s9 offen offset:256
    buffer_load_dword v96, v5, s[12:15], s9 offen offset:512
    buffer_load_dword v97, v5, s[12:15], s9 offen offset:768
    buffer_load_dword v98, v5, s[12:15], s9 offen offset:1024
    buffer_load_dword v99, v5, s[12:15], s9 offen offset:1280
    s_movk_i32 s9, 8208
    buffer_load_dword v100, v5, s[12:15], s9 offen offset:0
    buffer_load_dword v101, v5, s[12:15], s9 offen offset:256
    buffer_load_dword v102, v5, s[12:15], s9 offen offset:512
    buffer_load_dword v103, v5, s[12:15], s9 offen offset:768
    buffer_load_dword v104, v5, s[12:15], s9 offen offset:1024
    buffer_load_dword v105, v5, s[12:15], s9 offen offset:1280
    s_movk_i32 s9, 9576
    buffer_load_dword v106, v5, s[12:15], s9 offen offset:0
    buffer_load_dword v107, v5, s[12:15], s9 offen offset:256
    buffer_load_dword v108, v5, s[12:15], s9 offen offset:512
    buffer_load_dword v109, v5, s[12:15], s9 offen offset:768
    buffer_load_dword v110, v5, s[12:15], s9 offen offset:1024
    buffer_load_dword v111, v5, s[12:15], s9 offen offset:1280
    s_movk_i32 s9, 10944
    buffer_load_dword v112, v5, s[12:15], s9 offen offset:0
    buffer_load_dword v113, v5, s[12:15], s9 offen offset:256
    buffer_load_dword v114, v5, s[12:15], s9 offen offset:512
    buffer_load_dword v115, v5, s[12:15], s9 offen offset:768
    buffer_load_dword v116, v5, s[12:15], s9 offen offset:1024
    buffer_load_dword v117, v5, s[12:15], s9 offen offset:1280
    s_movk_i32 s9, 12312
    buffer_load_dword v118, v5, s[12:15], s9 offen offset:0
    buffer_load_dword v119, v5, s[12:15], s9 offen offset:256
    buffer_load_dword v120, v5, s[12:15], s9 offen offset:512
    buffer_load_dword v121, v5, s[12:15], s9 offen offset:768
    buffer_load_dword v122, v5, s[12:15], s9 offen offset:1024
    buffer_load_dword v123, v5, s[12:15], s9 offen offset:1280
    s_movk_i32 s9, 13680
    buffer_load_dword v124, v5, s[12:15], s9 offen offset:0
    buffer_load_dword v125, v5, s[12:15], s9 offen offset:256
    buffer_load_dword v126, v5, s[12:15], s9 offen offset:512
    buffer_load_dword v127, v5, s[12:15], s9 offen offset:768
    buffer_load_dword v128, v5, s[12:15], s9 offen offset:1024
    buffer_load_dword v129, v5, s[12:15], s9 offen offset:1280
    s_movk_i32 s9, 15048
    buffer_load_dword v130, v5, s[12:15], s9 offen offset:0
    buffer_load_dword v131, v5, s[12:15], s9 offen offset:256
    buffer_load_dword v132, v5, s[12:15], s9 offen offset:512
    buffer_load_dword v133, v5, s[12:15], s9 offen offset:768
    buffer_load_dword v134, v5, s[12:15], s9 offen offset:1024
    buffer_load_dword v135, v5, s[12:15], s9 offen offset:1280
    s_movk_i32 s9, 16416
    buffer_load_dword v136, v5, s[12:15], s9 offen offset:0
    buffer_load_dword v137, v5, s[12:15], s9 offen offset:256
    buffer_load_dword v138, v5, s[12:15], s9 offen offset:512
    buffer_load_dword v139, v5, s[12:15], s9 offen offset:768
    buffer_load_dword v140, v5, s[12:15], s9 offen offset:1024
    buffer_load_dword v141, v5, s[12:15], s9 offen offset:1280
    s_movk_i32 s9, 17784
    buffer_load_dword v142, v5, s[12:15], s9 offen offset:0
    buffer_load_dword v143, v5, s[12:15], s9 offen offset:256
    buffer_load_dword v144, v5, s[12:15], s9 offen offset:512
    buffer_load_dword v145, v5, s[12:15], s9 offen offset:768
    buffer_load_dword v146, v5, s[12:15], s9 offen offset:1024
    buffer_load_dword v147, v5, s[12:15], s9 offen offset:1280
    s_movk_i32 s9, 19152
    buffer_load_dword v148, v5, s[12:15], s9 offen offset:0
    buffer_load_dword v149, v5, s[12:15], s9 offen offset:256
    buffer_load_dword v150, v5, s[12:15], s9 offen offset:512
    buffer_load_dword v151, v5, s[12:15], s9 offen offset:768
    buffer_load_dword v152, v5, s[12:15], s9 offen offset:1024
    buffer_load_dword v153, v5, s[12:15], s9 offen offset:1280
    s_movk_i32 s9, 20520
    buffer_load_dword v154, v5, s[12:15], s9 offen offset:0
    buffer_load_dword v155, v5, s[12:15], s9 offen offset:256
    buffer_load_dword v156, v5, s[12:15], s9 offen offset:512
    buffer_load_dword v157, v5, s[12:15], s9 offen offset:768
    buffer_load_dword v158, v5, s[12:15], s9 offen offset:1024
    buffer_load_dword v159, v5, s[12:15], s9 offen offset:1280
    s_waitcnt vmcnt(0)
    v_add_f32 v64, v64, v70
    v_add_f32 v64, v64, v76
    v_add_f32 v64, v64, v82
    v_add_f32 v64, v64, v88
    v_add_f32 v64, v64, v94
    v_add_f32 v64, v64, v100
    v_add_f32 v64, v64, v106
    v_add_f32 v64, v64, v112
    v_add_f32 v64, v64, v118
    v_add_f32 v64, v64, v124
    v_add_f32 v64, v64, v130
    v_add_f32 v64, v64, v136
    v_add_f32 v64, v64, v142
    v_add_f32 v64, v64, v148
    v_add_f32 v64, v64, v154
    v_cvt_pk_bf16_f32 v64, v64, v64
    v_lshlrev_b32 v64, 16, v64
    ds_write_b32 v6, v64 offset:0
    v_add_f32 v65, v65, v71
    v_add_f32 v65, v65, v77
    v_add_f32 v65, v65, v83
    v_add_f32 v65, v65, v89
    v_add_f32 v65, v65, v95
    v_add_f32 v65, v65, v101
    v_add_f32 v65, v65, v107
    v_add_f32 v65, v65, v113
    v_add_f32 v65, v65, v119
    v_add_f32 v65, v65, v125
    v_add_f32 v65, v65, v131
    v_add_f32 v65, v65, v137
    v_add_f32 v65, v65, v143
    v_add_f32 v65, v65, v149
    v_add_f32 v65, v65, v155
    v_cvt_pk_bf16_f32 v65, v65, v65
    v_lshlrev_b32 v65, 16, v65
    ds_write_b32 v6, v65 offset:256
    v_add_f32 v66, v66, v72
    v_add_f32 v66, v66, v78
    v_add_f32 v66, v66, v84
    v_add_f32 v66, v66, v90
    v_add_f32 v66, v66, v96
    v_add_f32 v66, v66, v102
    v_add_f32 v66, v66, v108
    v_add_f32 v66, v66, v114
    v_add_f32 v66, v66, v120
    v_add_f32 v66, v66, v126
    v_add_f32 v66, v66, v132
    v_add_f32 v66, v66, v138
    v_add_f32 v66, v66, v144
    v_add_f32 v66, v66, v150
    v_add_f32 v66, v66, v156
    v_cvt_pk_bf16_f32 v66, v66, v66
    v_lshlrev_b32 v66, 16, v66
    ds_write_b32 v6, v66 offset:512
    v_add_f32 v67, v67, v73
    v_add_f32 v67, v67, v79
    v_add_f32 v67, v67, v85
    v_add_f32 v67, v67, v91
    v_add_f32 v67, v67, v97
    v_add_f32 v67, v67, v103
    v_add_f32 v67, v67, v109
    v_add_f32 v67, v67, v115
    v_add_f32 v67, v67, v121
    v_add_f32 v67, v67, v127
    v_add_f32 v67, v67, v133
    v_add_f32 v67, v67, v139
    v_add_f32 v67, v67, v145
    v_add_f32 v67, v67, v151
    v_add_f32 v67, v67, v157
    v_cvt_pk_bf16_f32 v67, v67, v67
    v_lshlrev_b32 v67, 16, v67
    ds_write_b32 v6, v67 offset:768
    v_add_f32 v68, v68, v74
    v_add_f32 v68, v68, v80
    v_add_f32 v68, v68, v86
    v_add_f32 v68, v68, v92
    v_add_f32 v68, v68, v98
    v_add_f32 v68, v68, v104
    v_add_f32 v68, v68, v110
    v_add_f32 v68, v68, v116
    v_add_f32 v68, v68, v122
    v_add_f32 v68, v68, v128
    v_add_f32 v68, v68, v134
    v_add_f32 v68, v68, v140
    v_add_f32 v68, v68, v146
    v_add_f32 v68, v68, v152
    v_add_f32 v68, v68, v158
    v_cvt_pk_bf16_f32 v68, v68, v68
    v_lshlrev_b32 v68, 16, v68
    ds_write_b32 v6, v68 offset:1024
    v_add_f32 v69, v69, v75
    v_add_f32 v69, v69, v81
    v_add_f32 v69, v69, v87
    v_add_f32 v69, v69, v93
    v_add_f32 v69, v69, v99
    v_add_f32 v69, v69, v105
    v_add_f32 v69, v69, v111
    v_add_f32 v69, v69, v117
    v_add_f32 v69, v69, v123
    v_add_f32 v69, v69, v129
    v_add_f32 v69, v69, v135
    v_add_f32 v69, v69, v141
    v_add_f32 v69, v69, v147
    v_add_f32 v69, v69, v153
    v_add_f32 v69, v69, v159
    v_cvt_pk_bf16_f32 v69, v69, v69
    v_lshlrev_b32 v69, 16, v69
    ds_write_b32 v6, v69 offset:1280
    v_lshlrev_b32 v32, 16, v16
    v_and_b32 v33, 0xffff0000, v16
    v_lshlrev_b32 v34, 16, v17
    v_and_b32 v35, 0xffff0000, v17
    v_lshlrev_b32 v36, 16, v18
    v_and_b32 v37, 0xffff0000, v18
    v_lshlrev_b32 v38, 16, v19
    v_and_b32 v39, 0xffff0000, v19
    v_lshlrev_b32 v40, 16, v20
    v_and_b32 v41, 0xffff0000, v20
    v_lshlrev_b32 v42, 16, v21
    v_and_b32 v43, 0xffff0000, v21
    v_lshlrev_b32 v44, 16, v22
    v_and_b32 v45, 0xffff0000, v22
    v_lshlrev_b32 v46, 16, v23
    v_and_b32 v47, 0xffff0000, v23
    v_lshlrev_b32 v48, 16, v24
    v_and_b32 v49, 0xffff0000, v24
    v_add_f32 v60, 1.0, v32
    v_mul_f32 v61, 0x3fb8aa3b, v32
    v_exp_f32 v61, v61
    v_cmp_lt_f32 vcc, 0, v32
    v_cndmask_b32 v32, v61, v60, vcc
    v_cvt_pk_bf16_f32 v32, v32, v32
    v_lshlrev_b32 v32, 16, v32
    v_add_f32 v32, 0x358637bd, v32
    v_cvt_pk_bf16_f32 v32, v32, v32
    v_lshlrev_b32 v32, 16, v32

    v_add_f32 v60, 1.0, v33
    v_mul_f32 v61, 0x3fb8aa3b, v33
    v_exp_f32 v61, v61
    v_cmp_lt_f32 vcc, 0, v33
    v_cndmask_b32 v33, v61, v60, vcc
    v_cvt_pk_bf16_f32 v33, v33, v33
    v_lshlrev_b32 v33, 16, v33
    v_add_f32 v33, 0x358637bd, v33
    v_cvt_pk_bf16_f32 v33, v33, v33
    v_lshlrev_b32 v33, 16, v33

    v_add_f32 v60, 1.0, v34
    v_mul_f32 v61, 0x3fb8aa3b, v34
    v_exp_f32 v61, v61
    v_cmp_lt_f32 vcc, 0, v34
    v_cndmask_b32 v34, v61, v60, vcc
    v_cvt_pk_bf16_f32 v34, v34, v34
    v_lshlrev_b32 v34, 16, v34
    v_add_f32 v34, 0x358637bd, v34
    v_cvt_pk_bf16_f32 v34, v34, v34
    v_lshlrev_b32 v34, 16, v34

    v_add_f32 v60, 1.0, v35
    v_mul_f32 v61, 0x3fb8aa3b, v35
    v_exp_f32 v61, v61
    v_cmp_lt_f32 vcc, 0, v35
    v_cndmask_b32 v35, v61, v60, vcc
    v_cvt_pk_bf16_f32 v35, v35, v35
    v_lshlrev_b32 v35, 16, v35
    v_add_f32 v35, 0x358637bd, v35
    v_cvt_pk_bf16_f32 v35, v35, v35
    v_lshlrev_b32 v35, 16, v35

    v_add_f32 v60, 1.0, v36
    v_mul_f32 v61, 0x3fb8aa3b, v36
    v_exp_f32 v61, v61
    v_cmp_lt_f32 vcc, 0, v36
    v_cndmask_b32 v36, v61, v60, vcc
    v_cvt_pk_bf16_f32 v36, v36, v36
    v_lshlrev_b32 v36, 16, v36
    v_add_f32 v36, 0x358637bd, v36
    v_cvt_pk_bf16_f32 v36, v36, v36
    v_lshlrev_b32 v36, 16, v36

    v_add_f32 v60, 1.0, v37
    v_mul_f32 v61, 0x3fb8aa3b, v37
    v_exp_f32 v61, v61
    v_cmp_lt_f32 vcc, 0, v37
    v_cndmask_b32 v37, v61, v60, vcc
    v_cvt_pk_bf16_f32 v37, v37, v37
    v_lshlrev_b32 v37, 16, v37
    v_add_f32 v37, 0x358637bd, v37
    v_cvt_pk_bf16_f32 v37, v37, v37
    v_lshlrev_b32 v37, 16, v37

    v_add_f32 v60, 1.0, v38
    v_mul_f32 v61, 0x3fb8aa3b, v38
    v_exp_f32 v61, v61
    v_cmp_lt_f32 vcc, 0, v38
    v_cndmask_b32 v38, v61, v60, vcc
    v_cvt_pk_bf16_f32 v38, v38, v38
    v_lshlrev_b32 v38, 16, v38
    v_add_f32 v38, 0x358637bd, v38
    v_cvt_pk_bf16_f32 v38, v38, v38
    v_lshlrev_b32 v38, 16, v38

    v_add_f32 v60, 1.0, v39
    v_mul_f32 v61, 0x3fb8aa3b, v39
    v_exp_f32 v61, v61
    v_cmp_lt_f32 vcc, 0, v39
    v_cndmask_b32 v39, v61, v60, vcc
    v_cvt_pk_bf16_f32 v39, v39, v39
    v_lshlrev_b32 v39, 16, v39
    v_add_f32 v39, 0x358637bd, v39
    v_cvt_pk_bf16_f32 v39, v39, v39
    v_lshlrev_b32 v39, 16, v39

    v_add_f32 v60, 1.0, v40
    v_mul_f32 v61, 0x3fb8aa3b, v40
    v_exp_f32 v61, v61
    v_cmp_lt_f32 vcc, 0, v40
    v_cndmask_b32 v40, v61, v60, vcc
    v_cvt_pk_bf16_f32 v40, v40, v40
    v_lshlrev_b32 v40, 16, v40
    v_add_f32 v40, 0x358637bd, v40
    v_cvt_pk_bf16_f32 v40, v40, v40
    v_lshlrev_b32 v40, 16, v40

    v_add_f32 v60, 1.0, v41
    v_mul_f32 v61, 0x3fb8aa3b, v41
    v_exp_f32 v61, v61
    v_cmp_lt_f32 vcc, 0, v41
    v_cndmask_b32 v41, v61, v60, vcc
    v_cvt_pk_bf16_f32 v41, v41, v41
    v_lshlrev_b32 v41, 16, v41
    v_add_f32 v41, 0x358637bd, v41
    v_cvt_pk_bf16_f32 v41, v41, v41
    v_lshlrev_b32 v41, 16, v41

    v_add_f32 v60, 1.0, v42
    v_mul_f32 v61, 0x3fb8aa3b, v42
    v_exp_f32 v61, v61
    v_cmp_lt_f32 vcc, 0, v42
    v_cndmask_b32 v42, v61, v60, vcc
    v_cvt_pk_bf16_f32 v42, v42, v42
    v_lshlrev_b32 v42, 16, v42
    v_add_f32 v42, 0x358637bd, v42
    v_cvt_pk_bf16_f32 v42, v42, v42
    v_lshlrev_b32 v42, 16, v42

    v_add_f32 v60, 1.0, v43
    v_mul_f32 v61, 0x3fb8aa3b, v43
    v_exp_f32 v61, v61
    v_cmp_lt_f32 vcc, 0, v43
    v_cndmask_b32 v43, v61, v60, vcc
    v_cvt_pk_bf16_f32 v43, v43, v43
    v_lshlrev_b32 v43, 16, v43
    v_add_f32 v43, 0x358637bd, v43
    v_cvt_pk_bf16_f32 v43, v43, v43
    v_lshlrev_b32 v43, 16, v43

    v_add_f32 v60, 1.0, v44
    v_mul_f32 v61, 0x3fb8aa3b, v44
    v_exp_f32 v61, v61
    v_cmp_lt_f32 vcc, 0, v44
    v_cndmask_b32 v44, v61, v60, vcc
    v_cvt_pk_bf16_f32 v44, v44, v44
    v_lshlrev_b32 v44, 16, v44
    v_add_f32 v44, 0x358637bd, v44
    v_cvt_pk_bf16_f32 v44, v44, v44
    v_lshlrev_b32 v44, 16, v44

    v_add_f32 v60, 1.0, v45
    v_mul_f32 v61, 0x3fb8aa3b, v45
    v_exp_f32 v61, v61
    v_cmp_lt_f32 vcc, 0, v45
    v_cndmask_b32 v45, v61, v60, vcc
    v_cvt_pk_bf16_f32 v45, v45, v45
    v_lshlrev_b32 v45, 16, v45
    v_add_f32 v45, 0x358637bd, v45
    v_cvt_pk_bf16_f32 v45, v45, v45
    v_lshlrev_b32 v45, 16, v45

    v_add_f32 v60, 1.0, v46
    v_mul_f32 v61, 0x3fb8aa3b, v46
    v_exp_f32 v61, v61
    v_cmp_lt_f32 vcc, 0, v46
    v_cndmask_b32 v46, v61, v60, vcc
    v_cvt_pk_bf16_f32 v46, v46, v46
    v_lshlrev_b32 v46, 16, v46
    v_add_f32 v46, 0x358637bd, v46
    v_cvt_pk_bf16_f32 v46, v46, v46
    v_lshlrev_b32 v46, 16, v46

    v_add_f32 v60, 1.0, v47
    v_mul_f32 v61, 0x3fb8aa3b, v47
    v_exp_f32 v61, v61
    v_cmp_lt_f32 vcc, 0, v47
    v_cndmask_b32 v47, v61, v60, vcc
    v_cvt_pk_bf16_f32 v47, v47, v47
    v_lshlrev_b32 v47, 16, v47
    v_add_f32 v47, 0x358637bd, v47
    v_cvt_pk_bf16_f32 v47, v47, v47
    v_lshlrev_b32 v47, 16, v47

    v_add_f32 v60, 1.0, v48
    v_mul_f32 v61, 0x3fb8aa3b, v48
    v_exp_f32 v61, v61
    v_cmp_lt_f32 vcc, 0, v48
    v_cndmask_b32 v48, v61, v60, vcc
    v_cvt_pk_bf16_f32 v48, v48, v48
    v_lshlrev_b32 v48, 16, v48
    v_add_f32 v48, 0x358637bd, v48
    v_cvt_pk_bf16_f32 v48, v48, v48
    v_lshlrev_b32 v48, 16, v48

    v_add_f32 v60, 1.0, v49
    v_mul_f32 v61, 0x3fb8aa3b, v49
    v_exp_f32 v61, v61
    v_cmp_lt_f32 vcc, 0, v49
    v_cndmask_b32 v49, v61, v60, vcc
    v_cvt_pk_bf16_f32 v49, v49, v49
    v_lshlrev_b32 v49, 16, v49
    v_add_f32 v49, 0x358637bd, v49
    v_cvt_pk_bf16_f32 v49, v49, v49
    v_lshlrev_b32 v49, 16, v49

    s_mul_i32 s9, s16, 1536
    v_mov_b32 v7, s9
    s_waitcnt lgkmcnt(0)
    ds_read_b128 v[96:99], v7 offset:1296
    ds_read_b128 v[100:103], v7 offset:1312
    ds_read_b128 v[104:107], v7 offset:1328
    ds_read_b128 v[108:111], v7 offset:1344
    ds_read_b64 v[112:113], v7 offset:1360
    v_mov_b32 v62, 0
    s_waitcnt lgkmcnt(0)
    v_fmac_f32 v62, v96, v32
    v_fmac_f32 v62, v97, v33
    v_fmac_f32 v62, v98, v34
    v_fmac_f32 v62, v99, v35
    v_fmac_f32 v62, v100, v36
    v_fmac_f32 v62, v101, v37
    v_fmac_f32 v62, v102, v38
    v_fmac_f32 v62, v103, v39
    v_fmac_f32 v62, v104, v40
    v_fmac_f32 v62, v105, v41
    v_fmac_f32 v62, v106, v42
    v_fmac_f32 v62, v107, v43
    v_fmac_f32 v62, v108, v44
    v_fmac_f32 v62, v109, v45
    v_fmac_f32 v62, v110, v46
    v_fmac_f32 v62, v111, v47
    v_fmac_f32 v62, v112, v48
    v_fmac_f32 v62, v113, v49
    v_cvt_pk_bf16_f32 v62, v62, v62
    v_lshlrev_b32 v62, 16, v62
    v_add_f32 v62, 0x358637bd, v62
    v_cvt_pk_bf16_f32 v62, v62, v62
    v_lshlrev_b32 v62, 16, v62
    v_rcp_f32 v63, v62
    v_mov_b32 v64, 0
    v_mov_b32 v65, 0
    v_mov_b32 v66, 0
    v_mov_b32 v67, 0
    v_mov_b32 v68, 0
    v_mov_b32 v69, 0
    v_mov_b32 v70, 0
    v_mov_b32 v71, 0
    v_mov_b32 v72, 0
    v_mov_b32 v73, 0
    v_mov_b32 v74, 0
    v_mov_b32 v75, 0
    v_mov_b32 v76, 0
    v_mov_b32 v77, 0
    v_mov_b32 v78, 0
    v_mov_b32 v79, 0
    v_mov_b32 v80, 0
    v_mov_b32 v81, 0
    ds_read_b128 v[96:99], v7 offset:0
    ds_read_b128 v[100:103], v7 offset:16
    ds_read_b128 v[104:107], v7 offset:32
    ds_read_b128 v[108:111], v7 offset:48
    ds_read_b64 v[112:113], v7 offset:64
    ds_read_b128 v[116:119], v7 offset:72
    ds_read_b128 v[120:123], v7 offset:88
    ds_read_b128 v[124:127], v7 offset:104
    ds_read_b128 v[128:131], v7 offset:120
    ds_read_b64 v[132:133], v7 offset:136
    s_waitcnt lgkmcnt(5)
    v_fmac_f32 v64, v96, v32
    v_fmac_f32 v65, v97, v32
    v_fmac_f32 v66, v98, v32
    v_fmac_f32 v67, v99, v32
    v_fmac_f32 v68, v100, v32
    v_fmac_f32 v69, v101, v32
    v_fmac_f32 v70, v102, v32
    v_fmac_f32 v71, v103, v32
    v_fmac_f32 v72, v104, v32
    v_fmac_f32 v73, v105, v32
    v_fmac_f32 v74, v106, v32
    v_fmac_f32 v75, v107, v32
    v_fmac_f32 v76, v108, v32
    v_fmac_f32 v77, v109, v32
    v_fmac_f32 v78, v110, v32
    v_fmac_f32 v79, v111, v32
    v_fmac_f32 v80, v112, v32
    v_fmac_f32 v81, v113, v32
    ds_read_b128 v[96:99], v7 offset:144
    ds_read_b128 v[100:103], v7 offset:160
    ds_read_b128 v[104:107], v7 offset:176
    ds_read_b128 v[108:111], v7 offset:192
    ds_read_b64 v[112:113], v7 offset:208
    s_waitcnt lgkmcnt(5)
    v_fmac_f32 v64, v116, v33
    v_fmac_f32 v65, v117, v33
    v_fmac_f32 v66, v118, v33
    v_fmac_f32 v67, v119, v33
    v_fmac_f32 v68, v120, v33
    v_fmac_f32 v69, v121, v33
    v_fmac_f32 v70, v122, v33
    v_fmac_f32 v71, v123, v33
    v_fmac_f32 v72, v124, v33
    v_fmac_f32 v73, v125, v33
    v_fmac_f32 v74, v126, v33
    v_fmac_f32 v75, v127, v33
    v_fmac_f32 v76, v128, v33
    v_fmac_f32 v77, v129, v33
    v_fmac_f32 v78, v130, v33
    v_fmac_f32 v79, v131, v33
    v_fmac_f32 v80, v132, v33
    v_fmac_f32 v81, v133, v33
    ds_read_b128 v[116:119], v7 offset:216
    ds_read_b128 v[120:123], v7 offset:232
    ds_read_b128 v[124:127], v7 offset:248
    ds_read_b128 v[128:131], v7 offset:264
    ds_read_b64 v[132:133], v7 offset:280
    s_waitcnt lgkmcnt(5)
    v_fmac_f32 v64, v96, v34
    v_fmac_f32 v65, v97, v34
    v_fmac_f32 v66, v98, v34
    v_fmac_f32 v67, v99, v34
    v_fmac_f32 v68, v100, v34
    v_fmac_f32 v69, v101, v34
    v_fmac_f32 v70, v102, v34
    v_fmac_f32 v71, v103, v34
    v_fmac_f32 v72, v104, v34
    v_fmac_f32 v73, v105, v34
    v_fmac_f32 v74, v106, v34
    v_fmac_f32 v75, v107, v34
    v_fmac_f32 v76, v108, v34
    v_fmac_f32 v77, v109, v34
    v_fmac_f32 v78, v110, v34
    v_fmac_f32 v79, v111, v34
    v_fmac_f32 v80, v112, v34
    v_fmac_f32 v81, v113, v34
    ds_read_b128 v[96:99], v7 offset:288
    ds_read_b128 v[100:103], v7 offset:304
    ds_read_b128 v[104:107], v7 offset:320
    ds_read_b128 v[108:111], v7 offset:336
    ds_read_b64 v[112:113], v7 offset:352
    s_waitcnt lgkmcnt(5)
    v_fmac_f32 v64, v116, v35
    v_fmac_f32 v65, v117, v35
    v_fmac_f32 v66, v118, v35
    v_fmac_f32 v67, v119, v35
    v_fmac_f32 v68, v120, v35
    v_fmac_f32 v69, v121, v35
    v_fmac_f32 v70, v122, v35
    v_fmac_f32 v71, v123, v35
    v_fmac_f32 v72, v124, v35
    v_fmac_f32 v73, v125, v35
    v_fmac_f32 v74, v126, v35
    v_fmac_f32 v75, v127, v35
    v_fmac_f32 v76, v128, v35
    v_fmac_f32 v77, v129, v35
    v_fmac_f32 v78, v130, v35
    v_fmac_f32 v79, v131, v35
    v_fmac_f32 v80, v132, v35
    v_fmac_f32 v81, v133, v35
    ds_read_b128 v[116:119], v7 offset:360
    ds_read_b128 v[120:123], v7 offset:376
    ds_read_b128 v[124:127], v7 offset:392
    ds_read_b128 v[128:131], v7 offset:408
    ds_read_b64 v[132:133], v7 offset:424
    s_waitcnt lgkmcnt(5)
    v_fmac_f32 v64, v96, v36
    v_fmac_f32 v65, v97, v36
    v_fmac_f32 v66, v98, v36
    v_fmac_f32 v67, v99, v36
    v_fmac_f32 v68, v100, v36
    v_fmac_f32 v69, v101, v36
    v_fmac_f32 v70, v102, v36
    v_fmac_f32 v71, v103, v36
    v_fmac_f32 v72, v104, v36
    v_fmac_f32 v73, v105, v36
    v_fmac_f32 v74, v106, v36
    v_fmac_f32 v75, v107, v36
    v_fmac_f32 v76, v108, v36
    v_fmac_f32 v77, v109, v36
    v_fmac_f32 v78, v110, v36
    v_fmac_f32 v79, v111, v36
    v_fmac_f32 v80, v112, v36
    v_fmac_f32 v81, v113, v36
    ds_read_b128 v[96:99], v7 offset:432
    ds_read_b128 v[100:103], v7 offset:448
    ds_read_b128 v[104:107], v7 offset:464
    ds_read_b128 v[108:111], v7 offset:480
    ds_read_b64 v[112:113], v7 offset:496
    s_waitcnt lgkmcnt(5)
    v_fmac_f32 v64, v116, v37
    v_fmac_f32 v65, v117, v37
    v_fmac_f32 v66, v118, v37
    v_fmac_f32 v67, v119, v37
    v_fmac_f32 v68, v120, v37
    v_fmac_f32 v69, v121, v37
    v_fmac_f32 v70, v122, v37
    v_fmac_f32 v71, v123, v37
    v_fmac_f32 v72, v124, v37
    v_fmac_f32 v73, v125, v37
    v_fmac_f32 v74, v126, v37
    v_fmac_f32 v75, v127, v37
    v_fmac_f32 v76, v128, v37
    v_fmac_f32 v77, v129, v37
    v_fmac_f32 v78, v130, v37
    v_fmac_f32 v79, v131, v37
    v_fmac_f32 v80, v132, v37
    v_fmac_f32 v81, v133, v37
    ds_read_b128 v[116:119], v7 offset:504
    ds_read_b128 v[120:123], v7 offset:520
    ds_read_b128 v[124:127], v7 offset:536
    ds_read_b128 v[128:131], v7 offset:552
    ds_read_b64 v[132:133], v7 offset:568
    s_waitcnt lgkmcnt(5)
    v_fmac_f32 v64, v96, v38
    v_fmac_f32 v65, v97, v38
    v_fmac_f32 v66, v98, v38
    v_fmac_f32 v67, v99, v38
    v_fmac_f32 v68, v100, v38
    v_fmac_f32 v69, v101, v38
    v_fmac_f32 v70, v102, v38
    v_fmac_f32 v71, v103, v38
    v_fmac_f32 v72, v104, v38
    v_fmac_f32 v73, v105, v38
    v_fmac_f32 v74, v106, v38
    v_fmac_f32 v75, v107, v38
    v_fmac_f32 v76, v108, v38
    v_fmac_f32 v77, v109, v38
    v_fmac_f32 v78, v110, v38
    v_fmac_f32 v79, v111, v38
    v_fmac_f32 v80, v112, v38
    v_fmac_f32 v81, v113, v38
    ds_read_b128 v[96:99], v7 offset:576
    ds_read_b128 v[100:103], v7 offset:592
    ds_read_b128 v[104:107], v7 offset:608
    ds_read_b128 v[108:111], v7 offset:624
    ds_read_b64 v[112:113], v7 offset:640
    s_waitcnt lgkmcnt(5)
    v_fmac_f32 v64, v116, v39
    v_fmac_f32 v65, v117, v39
    v_fmac_f32 v66, v118, v39
    v_fmac_f32 v67, v119, v39
    v_fmac_f32 v68, v120, v39
    v_fmac_f32 v69, v121, v39
    v_fmac_f32 v70, v122, v39
    v_fmac_f32 v71, v123, v39
    v_fmac_f32 v72, v124, v39
    v_fmac_f32 v73, v125, v39
    v_fmac_f32 v74, v126, v39
    v_fmac_f32 v75, v127, v39
    v_fmac_f32 v76, v128, v39
    v_fmac_f32 v77, v129, v39
    v_fmac_f32 v78, v130, v39
    v_fmac_f32 v79, v131, v39
    v_fmac_f32 v80, v132, v39
    v_fmac_f32 v81, v133, v39
    ds_read_b128 v[116:119], v7 offset:648
    ds_read_b128 v[120:123], v7 offset:664
    ds_read_b128 v[124:127], v7 offset:680
    ds_read_b128 v[128:131], v7 offset:696
    ds_read_b64 v[132:133], v7 offset:712
    s_waitcnt lgkmcnt(5)
    v_fmac_f32 v64, v96, v40
    v_fmac_f32 v65, v97, v40
    v_fmac_f32 v66, v98, v40
    v_fmac_f32 v67, v99, v40
    v_fmac_f32 v68, v100, v40
    v_fmac_f32 v69, v101, v40
    v_fmac_f32 v70, v102, v40
    v_fmac_f32 v71, v103, v40
    v_fmac_f32 v72, v104, v40
    v_fmac_f32 v73, v105, v40
    v_fmac_f32 v74, v106, v40
    v_fmac_f32 v75, v107, v40
    v_fmac_f32 v76, v108, v40
    v_fmac_f32 v77, v109, v40
    v_fmac_f32 v78, v110, v40
    v_fmac_f32 v79, v111, v40
    v_fmac_f32 v80, v112, v40
    v_fmac_f32 v81, v113, v40
    ds_read_b128 v[96:99], v7 offset:720
    ds_read_b128 v[100:103], v7 offset:736
    ds_read_b128 v[104:107], v7 offset:752
    ds_read_b128 v[108:111], v7 offset:768
    ds_read_b64 v[112:113], v7 offset:784
    s_waitcnt lgkmcnt(5)
    v_fmac_f32 v64, v116, v41
    v_fmac_f32 v65, v117, v41
    v_fmac_f32 v66, v118, v41
    v_fmac_f32 v67, v119, v41
    v_fmac_f32 v68, v120, v41
    v_fmac_f32 v69, v121, v41
    v_fmac_f32 v70, v122, v41
    v_fmac_f32 v71, v123, v41
    v_fmac_f32 v72, v124, v41
    v_fmac_f32 v73, v125, v41
    v_fmac_f32 v74, v126, v41
    v_fmac_f32 v75, v127, v41
    v_fmac_f32 v76, v128, v41
    v_fmac_f32 v77, v129, v41
    v_fmac_f32 v78, v130, v41
    v_fmac_f32 v79, v131, v41
    v_fmac_f32 v80, v132, v41
    v_fmac_f32 v81, v133, v41
    ds_read_b128 v[116:119], v7 offset:792
    ds_read_b128 v[120:123], v7 offset:808
    ds_read_b128 v[124:127], v7 offset:824
    ds_read_b128 v[128:131], v7 offset:840
    ds_read_b64 v[132:133], v7 offset:856
    s_waitcnt lgkmcnt(5)
    v_fmac_f32 v64, v96, v42
    v_fmac_f32 v65, v97, v42
    v_fmac_f32 v66, v98, v42
    v_fmac_f32 v67, v99, v42
    v_fmac_f32 v68, v100, v42
    v_fmac_f32 v69, v101, v42
    v_fmac_f32 v70, v102, v42
    v_fmac_f32 v71, v103, v42
    v_fmac_f32 v72, v104, v42
    v_fmac_f32 v73, v105, v42
    v_fmac_f32 v74, v106, v42
    v_fmac_f32 v75, v107, v42
    v_fmac_f32 v76, v108, v42
    v_fmac_f32 v77, v109, v42
    v_fmac_f32 v78, v110, v42
    v_fmac_f32 v79, v111, v42
    v_fmac_f32 v80, v112, v42
    v_fmac_f32 v81, v113, v42
    ds_read_b128 v[96:99], v7 offset:864
    ds_read_b128 v[100:103], v7 offset:880
    ds_read_b128 v[104:107], v7 offset:896
    ds_read_b128 v[108:111], v7 offset:912
    ds_read_b64 v[112:113], v7 offset:928
    s_waitcnt lgkmcnt(5)
    v_fmac_f32 v64, v116, v43
    v_fmac_f32 v65, v117, v43
    v_fmac_f32 v66, v118, v43
    v_fmac_f32 v67, v119, v43
    v_fmac_f32 v68, v120, v43
    v_fmac_f32 v69, v121, v43
    v_fmac_f32 v70, v122, v43
    v_fmac_f32 v71, v123, v43
    v_fmac_f32 v72, v124, v43
    v_fmac_f32 v73, v125, v43
    v_fmac_f32 v74, v126, v43
    v_fmac_f32 v75, v127, v43
    v_fmac_f32 v76, v128, v43
    v_fmac_f32 v77, v129, v43
    v_fmac_f32 v78, v130, v43
    v_fmac_f32 v79, v131, v43
    v_fmac_f32 v80, v132, v43
    v_fmac_f32 v81, v133, v43
    ds_read_b128 v[116:119], v7 offset:936
    ds_read_b128 v[120:123], v7 offset:952
    ds_read_b128 v[124:127], v7 offset:968
    ds_read_b128 v[128:131], v7 offset:984
    ds_read_b64 v[132:133], v7 offset:1000
    s_waitcnt lgkmcnt(5)
    v_fmac_f32 v64, v96, v44
    v_fmac_f32 v65, v97, v44
    v_fmac_f32 v66, v98, v44
    v_fmac_f32 v67, v99, v44
    v_fmac_f32 v68, v100, v44
    v_fmac_f32 v69, v101, v44
    v_fmac_f32 v70, v102, v44
    v_fmac_f32 v71, v103, v44
    v_fmac_f32 v72, v104, v44
    v_fmac_f32 v73, v105, v44
    v_fmac_f32 v74, v106, v44
    v_fmac_f32 v75, v107, v44
    v_fmac_f32 v76, v108, v44
    v_fmac_f32 v77, v109, v44
    v_fmac_f32 v78, v110, v44
    v_fmac_f32 v79, v111, v44
    v_fmac_f32 v80, v112, v44
    v_fmac_f32 v81, v113, v44
    ds_read_b128 v[96:99], v7 offset:1008
    ds_read_b128 v[100:103], v7 offset:1024
    ds_read_b128 v[104:107], v7 offset:1040
    ds_read_b128 v[108:111], v7 offset:1056
    ds_read_b64 v[112:113], v7 offset:1072
    s_waitcnt lgkmcnt(5)
    v_fmac_f32 v64, v116, v45
    v_fmac_f32 v65, v117, v45
    v_fmac_f32 v66, v118, v45
    v_fmac_f32 v67, v119, v45
    v_fmac_f32 v68, v120, v45
    v_fmac_f32 v69, v121, v45
    v_fmac_f32 v70, v122, v45
    v_fmac_f32 v71, v123, v45
    v_fmac_f32 v72, v124, v45
    v_fmac_f32 v73, v125, v45
    v_fmac_f32 v74, v126, v45
    v_fmac_f32 v75, v127, v45
    v_fmac_f32 v76, v128, v45
    v_fmac_f32 v77, v129, v45
    v_fmac_f32 v78, v130, v45
    v_fmac_f32 v79, v131, v45
    v_fmac_f32 v80, v132, v45
    v_fmac_f32 v81, v133, v45
    ds_read_b128 v[116:119], v7 offset:1080
    ds_read_b128 v[120:123], v7 offset:1096
    ds_read_b128 v[124:127], v7 offset:1112
    ds_read_b128 v[128:131], v7 offset:1128
    ds_read_b64 v[132:133], v7 offset:1144
    s_waitcnt lgkmcnt(5)
    v_fmac_f32 v64, v96, v46
    v_fmac_f32 v65, v97, v46
    v_fmac_f32 v66, v98, v46
    v_fmac_f32 v67, v99, v46
    v_fmac_f32 v68, v100, v46
    v_fmac_f32 v69, v101, v46
    v_fmac_f32 v70, v102, v46
    v_fmac_f32 v71, v103, v46
    v_fmac_f32 v72, v104, v46
    v_fmac_f32 v73, v105, v46
    v_fmac_f32 v74, v106, v46
    v_fmac_f32 v75, v107, v46
    v_fmac_f32 v76, v108, v46
    v_fmac_f32 v77, v109, v46
    v_fmac_f32 v78, v110, v46
    v_fmac_f32 v79, v111, v46
    v_fmac_f32 v80, v112, v46
    v_fmac_f32 v81, v113, v46
    ds_read_b128 v[96:99], v7 offset:1152
    ds_read_b128 v[100:103], v7 offset:1168
    ds_read_b128 v[104:107], v7 offset:1184
    ds_read_b128 v[108:111], v7 offset:1200
    ds_read_b64 v[112:113], v7 offset:1216
    s_waitcnt lgkmcnt(5)
    v_fmac_f32 v64, v116, v47
    v_fmac_f32 v65, v117, v47
    v_fmac_f32 v66, v118, v47
    v_fmac_f32 v67, v119, v47
    v_fmac_f32 v68, v120, v47
    v_fmac_f32 v69, v121, v47
    v_fmac_f32 v70, v122, v47
    v_fmac_f32 v71, v123, v47
    v_fmac_f32 v72, v124, v47
    v_fmac_f32 v73, v125, v47
    v_fmac_f32 v74, v126, v47
    v_fmac_f32 v75, v127, v47
    v_fmac_f32 v76, v128, v47
    v_fmac_f32 v77, v129, v47
    v_fmac_f32 v78, v130, v47
    v_fmac_f32 v79, v131, v47
    v_fmac_f32 v80, v132, v47
    v_fmac_f32 v81, v133, v47
    ds_read_b128 v[116:119], v7 offset:1224
    ds_read_b128 v[120:123], v7 offset:1240
    ds_read_b128 v[124:127], v7 offset:1256
    ds_read_b128 v[128:131], v7 offset:1272
    ds_read_b64 v[132:133], v7 offset:1288
    s_waitcnt lgkmcnt(5)
    v_fmac_f32 v64, v96, v48
    v_fmac_f32 v65, v97, v48
    v_fmac_f32 v66, v98, v48
    v_fmac_f32 v67, v99, v48
    v_fmac_f32 v68, v100, v48
    v_fmac_f32 v69, v101, v48
    v_fmac_f32 v70, v102, v48
    v_fmac_f32 v71, v103, v48
    v_fmac_f32 v72, v104, v48
    v_fmac_f32 v73, v105, v48
    v_fmac_f32 v74, v106, v48
    v_fmac_f32 v75, v107, v48
    v_fmac_f32 v76, v108, v48
    v_fmac_f32 v77, v109, v48
    v_fmac_f32 v78, v110, v48
    v_fmac_f32 v79, v111, v48
    v_fmac_f32 v80, v112, v48
    v_fmac_f32 v81, v113, v48
    s_waitcnt lgkmcnt(0)
    v_fmac_f32 v64, v116, v49
    v_fmac_f32 v65, v117, v49
    v_fmac_f32 v66, v118, v49
    v_fmac_f32 v67, v119, v49
    v_fmac_f32 v68, v120, v49
    v_fmac_f32 v69, v121, v49
    v_fmac_f32 v70, v122, v49
    v_fmac_f32 v71, v123, v49
    v_fmac_f32 v72, v124, v49
    v_fmac_f32 v73, v125, v49
    v_fmac_f32 v74, v126, v49
    v_fmac_f32 v75, v127, v49
    v_fmac_f32 v76, v128, v49
    v_fmac_f32 v77, v129, v49
    v_fmac_f32 v78, v130, v49
    v_fmac_f32 v79, v131, v49
    v_fmac_f32 v80, v132, v49
    v_fmac_f32 v81, v133, v49
    v_cvt_pk_bf16_f32 v64, v64, v64
    v_lshlrev_b32 v64, 16, v64
    v_mul_f32 v64, v64, v63
    v_cvt_pk_bf16_f32 v65, v65, v65
    v_lshlrev_b32 v65, 16, v65
    v_mul_f32 v65, v65, v63
    v_cvt_pk_bf16_f32 v66, v66, v66
    v_lshlrev_b32 v66, 16, v66
    v_mul_f32 v66, v66, v63
    v_cvt_pk_bf16_f32 v67, v67, v67
    v_lshlrev_b32 v67, 16, v67
    v_mul_f32 v67, v67, v63
    v_cvt_pk_bf16_f32 v68, v68, v68
    v_lshlrev_b32 v68, 16, v68
    v_mul_f32 v68, v68, v63
    v_cvt_pk_bf16_f32 v69, v69, v69
    v_lshlrev_b32 v69, 16, v69
    v_mul_f32 v69, v69, v63
    v_cvt_pk_bf16_f32 v70, v70, v70
    v_lshlrev_b32 v70, 16, v70
    v_mul_f32 v70, v70, v63
    v_cvt_pk_bf16_f32 v71, v71, v71
    v_lshlrev_b32 v71, 16, v71
    v_mul_f32 v71, v71, v63
    v_cvt_pk_bf16_f32 v72, v72, v72
    v_lshlrev_b32 v72, 16, v72
    v_mul_f32 v72, v72, v63
    v_cvt_pk_bf16_f32 v73, v73, v73
    v_lshlrev_b32 v73, 16, v73
    v_mul_f32 v73, v73, v63
    v_cvt_pk_bf16_f32 v74, v74, v74
    v_lshlrev_b32 v74, 16, v74
    v_mul_f32 v74, v74, v63
    v_cvt_pk_bf16_f32 v75, v75, v75
    v_lshlrev_b32 v75, 16, v75
    v_mul_f32 v75, v75, v63
    v_cvt_pk_bf16_f32 v76, v76, v76
    v_lshlrev_b32 v76, 16, v76
    v_mul_f32 v76, v76, v63
    v_cvt_pk_bf16_f32 v77, v77, v77
    v_lshlrev_b32 v77, 16, v77
    v_mul_f32 v77, v77, v63
    v_cvt_pk_bf16_f32 v78, v78, v78
    v_lshlrev_b32 v78, 16, v78
    v_mul_f32 v78, v78, v63
    v_cvt_pk_bf16_f32 v79, v79, v79
    v_lshlrev_b32 v79, 16, v79
    v_mul_f32 v79, v79, v63
    v_cvt_pk_bf16_f32 v80, v80, v80
    v_lshlrev_b32 v80, 16, v80
    v_mul_f32 v80, v80, v63
    v_cvt_pk_bf16_f32 v81, v81, v81
    v_lshlrev_b32 v81, 16, v81
    v_mul_f32 v81, v81, v63
    v_add_u32 v3, s5, v1
    s_movk_i32 s7, 1152
    v_mul_lo_u32 v3, v3, s7
    s_mul_i32 s8, s4, 36
    s_add_u32 s8, s8, 33554432
    v_add_u32 v3, s8, v3

    v_cvt_pk_bf16_f32 v16, v64, v65
    v_cvt_pk_bf16_f32 v17, v66, v67
    v_cvt_pk_bf16_f32 v18, v68, v69
    v_cvt_pk_bf16_f32 v19, v70, v71
    v_cvt_pk_bf16_f32 v20, v72, v73
    v_cvt_pk_bf16_f32 v21, v74, v75
    v_cvt_pk_bf16_f32 v22, v76, v77
    v_cvt_pk_bf16_f32 v23, v78, v79
    v_cvt_pk_bf16_f32 v24, v80, v81
    buffer_store_dwordx4 v[16:19], v3, s[12:15], 0 offen
    buffer_store_dwordx4 v[20:23], v3, s[12:15], 0 offen offset:16
    buffer_store_dword v24, v3, s[12:15], 0 offen offset:32
ko_done:
    s_endpgm
.globl k2_kernel
.p2align 8
.type k2_kernel,@function
k2_kernel:
    s_load_dwordx2 s[40:41], s[0:1], 16
    s_load_dwordx2 s[44:45], s[0:1], 40
    s_load_dwordx2 s[46:47], s[0:1], 72
    s_cmp_ge_u32 s2, 448
    s_cbranch_scc1 k2_done

    v_and_b32 v1, 63, v0
    v_lshrrev_b32 v11, 6, v0
    s_nop 0
    v_readfirstlane_b32 s16, v11

    s_waitcnt lgkmcnt(0)
    s_mov_b32 s4, s46
    s_mov_b32 s5, s47
    s_mov_b32 s6, 268435456
    s_mov_b32 s7, 0x00020000
    s_mov_b32 s12, s46
    s_mov_b32 s13, s47
    s_mov_b32 s14, 268435456
    s_mov_b32 s15, 0x00020000
    s_mul_hi_u32 s3, s2, 613566757
    s_mul_i32 s35, s3, 7
    s_sub_u32 s35, s2, s35
    s_and_b32 s19, s3, 3
    s_lshr_b32 s17, s3, 2
    s_lshl_b32 s17, s17, 7
    s_mul_i32 s18, s19, 288
    s_mov_b32 s33, 2304
    s_mul_i32 s34, s35, 4718592
    s_add_u32 s34, s34, 50331648
    s_cmp_eq_u32 s35, 6
    s_cbranch_scc1 k2_att

    s_mov_b32 s8, s44
    s_mov_b32 s9, s45
    s_mov_b32 s10, 5308416
    s_mov_b32 s11, 0x00020000
    s_mul_i32 s24, s35, 1536
    s_mul_i32 s25, s35, 884736
    v_lshrrev_b32 v11, 3, v1
    s_lshl_b32 s22, s16, 5
    s_add_u32 s22, s22, s17
    v_add_u32 v12, s22, v11
    s_mov_b32 s23, 9216
    v_mul_lo_u32 v2, v12, s23
    v_lshrrev_b32 v12, 1, v11
    v_and_b32 v12, 7, v12
    v_and_b32 v13, 7, v1
    v_xor_b32 v12, v12, v13
    v_lshlrev_b32 v12, 4, v12
    v_xor_b32 v13, 64, v12
    v_add_u32 v105, v2, v13
    v_add_u32 v2, v2, v12
    v_and_b32 v11, 15, v1
    v_lshrrev_b32 v12, 4, v1
    v_lshrrev_b32 v13, 1, v11
    v_and_b32 v13, 7, v13
    v_xor_b32 v14, v12, v13
    v_lshlrev_b32 v14, 4, v14
    v_xor_b32 v15, 4, v12
    v_xor_b32 v15, v15, v13
    v_lshlrev_b32 v15, 4, v15
    s_lshl_b32 s22, s16, 12
    v_lshlrev_b32 v11, 7, v11
    v_add_u32 v11, s22, v11
    v_add_u32 v11, 36864, v11
    v_add_u32 v3, v11, v14
    v_add_u32 v104, v11, v15

    s_mul_i32 s22, s16, 288
    s_add_u32 s22, s22, 0
    v_add_u32 v11, s22, v1
    s_movk_i32 s23, 3641
    v_mul_lo_u32 v12, v11, s23
    v_lshrrev_b32 v12, 16, v12
    v_mul_u32_u24 v13, 18, v12
    v_sub_u32 v13, v11, v13
    v_lshrrev_b32 v14, 3, v12
    v_and_b32 v14, 1, v14
    v_lshlrev_b32 v14, 2, v14
    v_xor_b32 v12, v12, v14
    s_mov_b32 s23, 1152
    v_mul_lo_u32 v12, v12, s23
    v_lshlrev_b32 v14, 4, v13
    v_add_u32 v12, v12, v14

    v_add_u32 v4, s18, v12
    s_mul_i32 s22, s16, 288
    s_add_u32 s22, s22, 64
    v_add_u32 v11, s22, v1
    s_movk_i32 s23, 3641
    v_mul_lo_u32 v12, v11, s23
    v_lshrrev_b32 v12, 16, v12
    v_mul_u32_u24 v13, 18, v12
    v_sub_u32 v13, v11, v13
    v_lshrrev_b32 v14, 3, v12
    v_and_b32 v14, 1, v14
    v_lshlrev_b32 v14, 2, v14
    v_xor_b32 v12, v12, v14
    s_mov_b32 s23, 1152
    v_mul_lo_u32 v12, v12, s23
    v_lshlrev_b32 v14, 4, v13
    v_add_u32 v12, v12, v14

    v_add_u32 v5, s18, v12
    s_mul_i32 s22, s16, 288
    s_add_u32 s22, s22, 128
    v_add_u32 v11, s22, v1
    s_movk_i32 s23, 3641
    v_mul_lo_u32 v12, v11, s23
    v_lshrrev_b32 v12, 16, v12
    v_mul_u32_u24 v13, 18, v12
    v_sub_u32 v13, v11, v13
    v_lshrrev_b32 v14, 3, v12
    v_and_b32 v14, 1, v14
    v_lshlrev_b32 v14, 2, v14
    v_xor_b32 v12, v12, v14
    s_mov_b32 s23, 1152
    v_mul_lo_u32 v12, v12, s23
    v_lshlrev_b32 v14, 4, v13
    v_add_u32 v12, v12, v14

    v_add_u32 v6, s18, v12
    s_mul_i32 s22, s16, 288
    s_add_u32 s22, s22, 192
    v_add_u32 v11, s22, v1
    s_movk_i32 s23, 3641
    v_mul_lo_u32 v12, v11, s23
    v_lshrrev_b32 v12, 16, v12
    v_mul_u32_u24 v13, 18, v12
    v_sub_u32 v13, v11, v13
    v_lshrrev_b32 v14, 3, v12
    v_and_b32 v14, 1, v14
    v_lshlrev_b32 v14, 2, v14
    v_xor_b32 v12, v12, v14
    s_mov_b32 s23, 1152
    v_mul_lo_u32 v12, v12, s23
    v_lshlrev_b32 v14, 4, v13
    v_add_u32 v12, v12, v14

    v_add_u32 v7, s18, v12
    s_mul_i32 s22, s16, 288
    s_add_u32 s22, s22, 256
    v_add_u32 v11, s22, v1
    s_movk_i32 s23, 3641
    v_mul_lo_u32 v12, v11, s23
    v_lshrrev_b32 v12, 16, v12
    v_mul_u32_u24 v13, 18, v12
    v_sub_u32 v13, v11, v13
    v_lshrrev_b32 v14, 3, v12
    v_and_b32 v14, 1, v14
    v_lshlrev_b32 v14, 2, v14
    v_xor_b32 v12, v12, v14
    s_mov_b32 s23, 1152
    v_mul_lo_u32 v12, v12, s23
    v_lshlrev_b32 v14, 4, v13
    v_add_u32 v12, v12, v14

    v_add_u32 v8, s18, v12
    v_lshrrev_b32 v11, 4, v1
    v_and_b32 v12, 15, v1
    v_lshrrev_b32 v13, 2, v12
    v_and_b32 v14, 3, v12
    v_and_b32 v15, 1, v11
    v_lshlrev_b32 v15, 2, v15
    v_lshlrev_b32 v11, 3, v11
    v_add_u32 v11, v11, v13
    v_add_u32 v12, v11, v15
    v_mul_u32_u24 v12, 288, v12
    v_lshlrev_b32 v14, 3, v14
    v_add_u32 v9, v12, v14
    v_xor_b32 v15, 4, v15
    v_add_u32 v12, v11, v15
    v_mul_u32_u24 v12, 288, v12
    v_add_u32 v10, v12, v14

    v_accvgpr_write_b32 a0, 0
    v_accvgpr_write_b32 a1, 0
    v_accvgpr_write_b32 a2, 0
    v_accvgpr_write_b32 a3, 0
    v_accvgpr_write_b32 a4, 0
    v_accvgpr_write_b32 a5, 0
    v_accvgpr_write_b32 a6, 0
    v_accvgpr_write_b32 a7, 0
    v_accvgpr_write_b32 a8, 0
    v_accvgpr_write_b32 a9, 0
    v_accvgpr_write_b32 a10, 0
    v_accvgpr_write_b32 a11, 0
    v_accvgpr_write_b32 a12, 0
    v_accvgpr_write_b32 a13, 0
    v_accvgpr_write_b32 a14, 0
    v_accvgpr_write_b32 a15, 0
    v_accvgpr_write_b32 a16, 0
    v_accvgpr_write_b32 a17, 0
    v_accvgpr_write_b32 a18, 0
    v_accvgpr_write_b32 a19, 0
    v_accvgpr_write_b32 a20, 0
    v_accvgpr_write_b32 a21, 0
    v_accvgpr_write_b32 a22, 0
    v_accvgpr_write_b32 a23, 0
    v_accvgpr_write_b32 a24, 0
    v_accvgpr_write_b32 a25, 0
    v_accvgpr_write_b32 a26, 0
    v_accvgpr_write_b32 a27, 0
    v_accvgpr_write_b32 a28, 0
    v_accvgpr_write_b32 a29, 0
    v_accvgpr_write_b32 a30, 0
    v_accvgpr_write_b32 a31, 0
    v_accvgpr_write_b32 a32, 0
    v_accvgpr_write_b32 a33, 0
    v_accvgpr_write_b32 a34, 0
    v_accvgpr_write_b32 a35, 0
    v_accvgpr_write_b32 a36, 0
    v_accvgpr_write_b32 a37, 0
    v_accvgpr_write_b32 a38, 0
    v_accvgpr_write_b32 a39, 0
    v_accvgpr_write_b32 a40, 0
    v_accvgpr_write_b32 a41, 0
    v_accvgpr_write_b32 a42, 0
    v_accvgpr_write_b32 a43, 0
    v_accvgpr_write_b32 a44, 0
    v_accvgpr_write_b32 a45, 0
    v_accvgpr_write_b32 a46, 0
    v_accvgpr_write_b32 a47, 0
    v_accvgpr_write_b32 a48, 0
    v_accvgpr_write_b32 a49, 0
    v_accvgpr_write_b32 a50, 0
    v_accvgpr_write_b32 a51, 0
    v_accvgpr_write_b32 a52, 0
    v_accvgpr_write_b32 a53, 0
    v_accvgpr_write_b32 a54, 0
    v_accvgpr_write_b32 a55, 0
    v_accvgpr_write_b32 a56, 0
    v_accvgpr_write_b32 a57, 0
    v_accvgpr_write_b32 a58, 0
    v_accvgpr_write_b32 a59, 0
    v_accvgpr_write_b32 a60, 0
    v_accvgpr_write_b32 a61, 0
    v_accvgpr_write_b32 a62, 0
    v_accvgpr_write_b32 a63, 0
    v_accvgpr_write_b32 a64, 0
    v_accvgpr_write_b32 a65, 0
    v_accvgpr_write_b32 a66, 0
    v_accvgpr_write_b32 a67, 0
    v_accvgpr_write_b32 a68, 0
    v_accvgpr_write_b32 a69, 0
    v_accvgpr_write_b32 a70, 0
    v_accvgpr_write_b32 a71, 0
    s_mul_i32 s26, s16, 4608
    s_lshl_b32 s31, s16, 12
    s_mov_b32 s29, 0x7ffffff0
    s_mov_b32 s28, 12
    s_mov_b32 s30, 12

    s_cmp_gt_i32 s28, 0
    s_cselect_b32 s22, s25, s29
    s_cselect_b32 s23, s24, s29
    s_add_u32 m0, s31, 36864
    s_add_u32 s27, s23, 0
    buffer_load_dwordx4 v2, s[4:7], s27 offen lds
    s_add_u32 m0, s31, 37888
    s_add_u32 s27, s23, 73728
    buffer_load_dwordx4 v105, s[4:7], s27 offen lds
    s_add_u32 m0, s31, 38912
    s_add_u32 s27, s23, 147456
    buffer_load_dwordx4 v2, s[4:7], s27 offen lds
    s_add_u32 m0, s31, 39936
    s_add_u32 s27, s23, 221184
    buffer_load_dwordx4 v105, s[4:7], s27 offen lds
    s_add_u32 m0, s26, 0
    s_nop 0
    buffer_load_dwordx4 v4, s[8:11], s22 offen lds
    s_add_u32 m0, s26, 1024
    s_nop 0
    buffer_load_dwordx4 v5, s[8:11], s22 offen lds
    s_add_u32 m0, s26, 2048
    s_nop 0
    buffer_load_dwordx4 v6, s[8:11], s22 offen lds
    s_add_u32 m0, s26, 3072
    s_nop 0
    buffer_load_dwordx4 v7, s[8:11], s22 offen lds
    s_add_u32 m0, s26, 4096
    s_mov_b64 exec, 0xffffffff
    buffer_load_dwordx4 v8, s[8:11], s22 offen lds
    s_mov_b64 exec, -1
    s_add_u32 s25, s25, 73728
    s_add_u32 s24, s24, 128
    s_sub_u32 s28, s28, 1
Lloop_7:
    s_waitcnt vmcnt(0)
    s_barrier
    s_cmp_gt_i32 s28, 0
    s_cselect_b32 s22, s25, s29
    s_cselect_b32 s23, s24, s29
    s_add_u32 m0, s31, 53248
    s_add_u32 s27, s23, 0
    buffer_load_dwordx4 v2, s[4:7], s27 offen lds
    s_add_u32 m0, s31, 54272
    s_add_u32 s27, s23, 73728
    buffer_load_dwordx4 v105, s[4:7], s27 offen lds
    s_add_u32 m0, s31, 55296
    s_add_u32 s27, s23, 147456
    buffer_load_dwordx4 v2, s[4:7], s27 offen lds
    s_add_u32 m0, s31, 56320
    s_add_u32 s27, s23, 221184
    buffer_load_dwordx4 v105, s[4:7], s27 offen lds
    s_add_u32 m0, s26, 18432
    s_nop 0
    buffer_load_dwordx4 v4, s[8:11], s22 offen lds
    s_add_u32 m0, s26, 19456
    s_nop 0
    buffer_load_dwordx4 v5, s[8:11], s22 offen lds
    s_add_u32 m0, s26, 20480
    s_nop 0
    buffer_load_dwordx4 v6, s[8:11], s22 offen lds
    s_add_u32 m0, s26, 21504
    s_nop 0
    buffer_load_dwordx4 v7, s[8:11], s22 offen lds
    s_add_u32 m0, s26, 22528
    s_mov_b64 exec, 0xffffffff
    buffer_load_dwordx4 v8, s[8:11], s22 offen lds
    s_mov_b64 exec, -1
    s_add_u32 s25, s25, 73728
    s_add_u32 s24, s24, 128
    s_sub_u32 s28, s28, 1
    ds_read_b128 v[16:19], v3 offset:0
    ds_read_b128 v[20:23], v104 offset:0
    ds_read_b128 v[24:27], v3 offset:2048
    ds_read_b128 v[28:31], v104 offset:2048
    ds_read_b64_tr_b16 v[80:81], v9 offset:0
    ds_read_b64_tr_b16 v[82:83], v10 offset:0
    ds_read_b64_tr_b16 v[84:85], v9 offset:32
    ds_read_b64_tr_b16 v[86:87], v10 offset:32
    ds_read_b64_tr_b16 v[88:89], v9 offset:64
    ds_read_b64_tr_b16 v[90:91], v10 offset:64
    ds_read_b64_tr_b16 v[92:93], v9 offset:96
    ds_read_b64_tr_b16 v[94:95], v10 offset:96
    ds_read_b64_tr_b16 v[96:97], v9 offset:128
    ds_read_b64_tr_b16 v[98:99], v10 offset:128
    s_waitcnt lgkmcnt(8)
    v_mfma_f32_16x16x32_bf16 a[0:3], v[80:83], v[16:19], a[0:3]
    v_mfma_f32_16x16x32_bf16 a[36:39], v[80:83], v[24:27], a[36:39]
    ds_read_b64_tr_b16 v[100:101], v9 offset:160
    ds_read_b64_tr_b16 v[102:103], v10 offset:160
    s_waitcnt lgkmcnt(8)
    v_mfma_f32_16x16x32_bf16 a[4:7], v[84:87], v[16:19], a[4:7]
    v_mfma_f32_16x16x32_bf16 a[40:43], v[84:87], v[24:27], a[40:43]
    ds_read_b64_tr_b16 v[80:81], v9 offset:192
    ds_read_b64_tr_b16 v[82:83], v10 offset:192
    s_waitcnt lgkmcnt(8)
    v_mfma_f32_16x16x32_bf16 a[8:11], v[88:91], v[16:19], a[8:11]
    v_mfma_f32_16x16x32_bf16 a[44:47], v[88:91], v[24:27], a[44:47]
    ds_read_b64_tr_b16 v[84:85], v9 offset:224
    ds_read_b64_tr_b16 v[86:87], v10 offset:224
    s_waitcnt lgkmcnt(8)
    v_mfma_f32_16x16x32_bf16 a[12:15], v[92:95], v[16:19], a[12:15]
    v_mfma_f32_16x16x32_bf16 a[48:51], v[92:95], v[24:27], a[48:51]
    ds_read_b64_tr_b16 v[88:89], v9 offset:256
    ds_read_b64_tr_b16 v[90:91], v10 offset:256
    s_waitcnt lgkmcnt(8)
    v_mfma_f32_16x16x32_bf16 a[16:19], v[96:99], v[16:19], a[16:19]
    v_mfma_f32_16x16x32_bf16 a[52:55], v[96:99], v[24:27], a[52:55]
    ds_read_b64_tr_b16 v[92:93], v9 offset:9216
    ds_read_b64_tr_b16 v[94:95], v10 offset:9216
    s_waitcnt lgkmcnt(8)
    v_mfma_f32_16x16x32_bf16 a[20:23], v[100:103], v[16:19], a[20:23]
    v_mfma_f32_16x16x32_bf16 a[56:59], v[100:103], v[24:27], a[56:59]
    ds_read_b64_tr_b16 v[96:97], v9 offset:9248
    ds_read_b64_tr_b16 v[98:99], v10 offset:9248
    s_waitcnt lgkmcnt(8)
    v_mfma_f32_16x16x32_bf16 a[24:27], v[80:83], v[16:19], a[24:27]
    v_mfma_f32_16x16x32_bf16 a[60:63], v[80:83], v[24:27], a[60:63]
    ds_read_b64_tr_b16 v[100:101], v9 offset:9280
    ds_read_b64_tr_b16 v[102:103], v10 offset:9280
    s_waitcnt lgkmcnt(8)
    v_mfma_f32_16x16x32_bf16 a[28:31], v[84:87], v[16:19], a[28:31]
    v_mfma_f32_16x16x32_bf16 a[64:67], v[84:87], v[24:27], a[64:67]
    ds_read_b64_tr_b16 v[80:81], v9 offset:9312
    ds_read_b64_tr_b16 v[82:83], v10 offset:9312
    s_waitcnt lgkmcnt(8)
    v_mfma_f32_16x16x32_bf16 a[32:35], v[88:91], v[16:19], a[32:35]
    v_mfma_f32_16x16x32_bf16 a[68:71], v[88:91], v[24:27], a[68:71]
    ds_read_b64_tr_b16 v[84:85], v9 offset:9344
    ds_read_b64_tr_b16 v[86:87], v10 offset:9344
    s_waitcnt lgkmcnt(8)
    v_mfma_f32_16x16x32_bf16 a[0:3], v[92:95], v[20:23], a[0:3]
    v_mfma_f32_16x16x32_bf16 a[36:39], v[92:95], v[28:31], a[36:39]
    ds_read_b64_tr_b16 v[88:89], v9 offset:9376
    ds_read_b64_tr_b16 v[90:91], v10 offset:9376
    s_waitcnt lgkmcnt(8)
    v_mfma_f32_16x16x32_bf16 a[4:7], v[96:99], v[20:23], a[4:7]
    v_mfma_f32_16x16x32_bf16 a[40:43], v[96:99], v[28:31], a[40:43]
    ds_read_b64_tr_b16 v[92:93], v9 offset:9408
    ds_read_b64_tr_b16 v[94:95], v10 offset:9408
    s_waitcnt lgkmcnt(8)
    v_mfma_f32_16x16x32_bf16 a[8:11], v[100:103], v[20:23], a[8:11]
    v_mfma_f32_16x16x32_bf16 a[44:47], v[100:103], v[28:31], a[44:47]
    ds_read_b64_tr_b16 v[96:97], v9 offset:9440
    ds_read_b64_tr_b16 v[98:99], v10 offset:9440
    s_waitcnt lgkmcnt(8)
    v_mfma_f32_16x16x32_bf16 a[12:15], v[80:83], v[20:23], a[12:15]
    v_mfma_f32_16x16x32_bf16 a[48:51], v[80:83], v[28:31], a[48:51]
    ds_read_b64_tr_b16 v[100:101], v9 offset:9472
    ds_read_b64_tr_b16 v[102:103], v10 offset:9472
    s_waitcnt lgkmcnt(8)
    v_mfma_f32_16x16x32_bf16 a[16:19], v[84:87], v[20:23], a[16:19]
    v_mfma_f32_16x16x32_bf16 a[52:55], v[84:87], v[28:31], a[52:55]
    s_waitcnt lgkmcnt(6)
    v_mfma_f32_16x16x32_bf16 a[20:23], v[88:91], v[20:23], a[20:23]
    v_mfma_f32_16x16x32_bf16 a[56:59], v[88:91], v[28:31], a[56:59]
    s_waitcnt lgkmcnt(4)
    v_mfma_f32_16x16x32_bf16 a[24:27], v[92:95], v[20:23], a[24:27]
    v_mfma_f32_16x16x32_bf16 a[60:63], v[92:95], v[28:31], a[60:63]
    s_waitcnt lgkmcnt(2)
    v_mfma_f32_16x16x32_bf16 a[28:31], v[96:99], v[20:23], a[28:31]
    v_mfma_f32_16x16x32_bf16 a[64:67], v[96:99], v[28:31], a[64:67]
    s_waitcnt lgkmcnt(0)
    v_mfma_f32_16x16x32_bf16 a[32:35], v[100:103], v[20:23], a[32:35]
    v_mfma_f32_16x16x32_bf16 a[68:71], v[100:103], v[28:31], a[68:71]
    s_sub_u32 s30, s30, 1
    s_cmp_eq_u32 s30, 0
    s_cbranch_scc1 Lend_8
    s_waitcnt vmcnt(0)
    s_barrier
    s_cmp_gt_i32 s28, 0
    s_cselect_b32 s22, s25, s29
    s_cselect_b32 s23, s24, s29
    s_add_u32 m0, s31, 36864
    s_add_u32 s27, s23, 0
    buffer_load_dwordx4 v2, s[4:7], s27 offen lds
    s_add_u32 m0, s31, 37888
    s_add_u32 s27, s23, 73728
    buffer_load_dwordx4 v105, s[4:7], s27 offen lds
    s_add_u32 m0, s31, 38912
    s_add_u32 s27, s23, 147456
    buffer_load_dwordx4 v2, s[4:7], s27 offen lds
    s_add_u32 m0, s31, 39936
    s_add_u32 s27, s23, 221184
    buffer_load_dwordx4 v105, s[4:7], s27 offen lds
    s_add_u32 m0, s26, 0
    s_nop 0
    buffer_load_dwordx4 v4, s[8:11], s22 offen lds
    s_add_u32 m0, s26, 1024
    s_nop 0
    buffer_load_dwordx4 v5, s[8:11], s22 offen lds
    s_add_u32 m0, s26, 2048
    s_nop 0
    buffer_load_dwordx4 v6, s[8:11], s22 offen lds
    s_add_u32 m0, s26, 3072
    s_nop 0
    buffer_load_dwordx4 v7, s[8:11], s22 offen lds
    s_add_u32 m0, s26, 4096
    s_mov_b64 exec, 0xffffffff
    buffer_load_dwordx4 v8, s[8:11], s22 offen lds
    s_mov_b64 exec, -1
    s_add_u32 s25, s25, 73728
    s_add_u32 s24, s24, 128
    s_sub_u32 s28, s28, 1
    ds_read_b128 v[16:19], v3 offset:16384
    ds_read_b128 v[20:23], v104 offset:16384
    ds_read_b128 v[24:27], v3 offset:18432
    ds_read_b128 v[28:31], v104 offset:18432
    ds_read_b64_tr_b16 v[80:81], v9 offset:18432
    ds_read_b64_tr_b16 v[82:83], v10 offset:18432
    ds_read_b64_tr_b16 v[84:85], v9 offset:18464
    ds_read_b64_tr_b16 v[86:87], v10 offset:18464
    ds_read_b64_tr_b16 v[88:89], v9 offset:18496
    ds_read_b64_tr_b16 v[90:91], v10 offset:18496
    ds_read_b64_tr_b16 v[92:93], v9 offset:18528
    ds_read_b64_tr_b16 v[94:95], v10 offset:18528
    ds_read_b64_tr_b16 v[96:97], v9 offset:18560
    ds_read_b64_tr_b16 v[98:99], v10 offset:18560
    s_waitcnt lgkmcnt(8)
    v_mfma_f32_16x16x32_bf16 a[0:3], v[80:83], v[16:19], a[0:3]
    v_mfma_f32_16x16x32_bf16 a[36:39], v[80:83], v[24:27], a[36:39]
    ds_read_b64_tr_b16 v[100:101], v9 offset:18592
    ds_read_b64_tr_b16 v[102:103], v10 offset:18592
    s_waitcnt lgkmcnt(8)
    v_mfma_f32_16x16x32_bf16 a[4:7], v[84:87], v[16:19], a[4:7]
    v_mfma_f32_16x16x32_bf16 a[40:43], v[84:87], v[24:27], a[40:43]
    ds_read_b64_tr_b16 v[80:81], v9 offset:18624
    ds_read_b64_tr_b16 v[82:83], v10 offset:18624
    s_waitcnt lgkmcnt(8)
    v_mfma_f32_16x16x32_bf16 a[8:11], v[88:91], v[16:19], a[8:11]
    v_mfma_f32_16x16x32_bf16 a[44:47], v[88:91], v[24:27], a[44:47]
    ds_read_b64_tr_b16 v[84:85], v9 offset:18656
    ds_read_b64_tr_b16 v[86:87], v10 offset:18656
    s_waitcnt lgkmcnt(8)
    v_mfma_f32_16x16x32_bf16 a[12:15], v[92:95], v[16:19], a[12:15]
    v_mfma_f32_16x16x32_bf16 a[48:51], v[92:95], v[24:27], a[48:51]
    ds_read_b64_tr_b16 v[88:89], v9 offset:18688
    ds_read_b64_tr_b16 v[90:91], v10 offset:18688
    s_waitcnt lgkmcnt(8)
    v_mfma_f32_16x16x32_bf16 a[16:19], v[96:99], v[16:19], a[16:19]
    v_mfma_f32_16x16x32_bf16 a[52:55], v[96:99], v[24:27], a[52:55]
    ds_read_b64_tr_b16 v[92:93], v9 offset:27648
    ds_read_b64_tr_b16 v[94:95], v10 offset:27648
    s_waitcnt lgkmcnt(8)
    v_mfma_f32_16x16x32_bf16 a[20:23], v[100:103], v[16:19], a[20:23]
    v_mfma_f32_16x16x32_bf16 a[56:59], v[100:103], v[24:27], a[56:59]
    ds_read_b64_tr_b16 v[96:97], v9 offset:27680
    ds_read_b64_tr_b16 v[98:99], v10 offset:27680
    s_waitcnt lgkmcnt(8)
    v_mfma_f32_16x16x32_bf16 a[24:27], v[80:83], v[16:19], a[24:27]
    v_mfma_f32_16x16x32_bf16 a[60:63], v[80:83], v[24:27], a[60:63]
    ds_read_b64_tr_b16 v[100:101], v9 offset:27712
    ds_read_b64_tr_b16 v[102:103], v10 offset:27712
    s_waitcnt lgkmcnt(8)
    v_mfma_f32_16x16x32_bf16 a[28:31], v[84:87], v[16:19], a[28:31]
    v_mfma_f32_16x16x32_bf16 a[64:67], v[84:87], v[24:27], a[64:67]
    ds_read_b64_tr_b16 v[80:81], v9 offset:27744
    ds_read_b64_tr_b16 v[82:83], v10 offset:27744
    s_waitcnt lgkmcnt(8)
    v_mfma_f32_16x16x32_bf16 a[32:35], v[88:91], v[16:19], a[32:35]
    v_mfma_f32_16x16x32_bf16 a[68:71], v[88:91], v[24:27], a[68:71]
    ds_read_b64_tr_b16 v[84:85], v9 offset:27776
    ds_read_b64_tr_b16 v[86:87], v10 offset:27776
    s_waitcnt lgkmcnt(8)
    v_mfma_f32_16x16x32_bf16 a[0:3], v[92:95], v[20:23], a[0:3]
    v_mfma_f32_16x16x32_bf16 a[36:39], v[92:95], v[28:31], a[36:39]
    ds_read_b64_tr_b16 v[88:89], v9 offset:27808
    ds_read_b64_tr_b16 v[90:91], v10 offset:27808
    s_waitcnt lgkmcnt(8)
    v_mfma_f32_16x16x32_bf16 a[4:7], v[96:99], v[20:23], a[4:7]
    v_mfma_f32_16x16x32_bf16 a[40:43], v[96:99], v[28:31], a[40:43]
    ds_read_b64_tr_b16 v[92:93], v9 offset:27840
    ds_read_b64_tr_b16 v[94:95], v10 offset:27840
    s_waitcnt lgkmcnt(8)
    v_mfma_f32_16x16x32_bf16 a[8:11], v[100:103], v[20:23], a[8:11]
    v_mfma_f32_16x16x32_bf16 a[44:47], v[100:103], v[28:31], a[44:47]
    ds_read_b64_tr_b16 v[96:97], v9 offset:27872
    ds_read_b64_tr_b16 v[98:99], v10 offset:27872
    s_waitcnt lgkmcnt(8)
    v_mfma_f32_16x16x32_bf16 a[12:15], v[80:83], v[20:23], a[12:15]
    v_mfma_f32_16x16x32_bf16 a[48:51], v[80:83], v[28:31], a[48:51]
    ds_read_b64_tr_b16 v[100:101], v9 offset:27904
    ds_read_b64_tr_b16 v[102:103], v10 offset:27904
    s_waitcnt lgkmcnt(8)
    v_mfma_f32_16x16x32_bf16 a[16:19], v[84:87], v[20:23], a[16:19]
    v_mfma_f32_16x16x32_bf16 a[52:55], v[84:87], v[28:31], a[52:55]
    s_waitcnt lgkmcnt(6)
    v_mfma_f32_16x16x32_bf16 a[20:23], v[88:91], v[20:23], a[20:23]
    v_mfma_f32_16x16x32_bf16 a[56:59], v[88:91], v[28:31], a[56:59]
    s_waitcnt lgkmcnt(4)
    v_mfma_f32_16x16x32_bf16 a[24:27], v[92:95], v[20:23], a[24:27]
    v_mfma_f32_16x16x32_bf16 a[60:63], v[92:95], v[28:31], a[60:63]
    s_waitcnt lgkmcnt(2)
    v_mfma_f32_16x16x32_bf16 a[28:31], v[96:99], v[20:23], a[28:31]
    v_mfma_f32_16x16x32_bf16 a[64:67], v[96:99], v[28:31], a[64:67]
    s_waitcnt lgkmcnt(0)
    v_mfma_f32_16x16x32_bf16 a[32:35], v[100:103], v[20:23], a[32:35]
    v_mfma_f32_16x16x32_bf16 a[68:71], v[100:103], v[28:31], a[68:71]
    s_sub_u32 s30, s30, 1
    s_cmp_eq_u32 s30, 0
    s_cbranch_scc0 Lloop_7
Lend_8:
    s_waitcnt vmcnt(0)
    s_lshl_b32 s18, s18, 1
    s_nop 7
    s_nop 7
    v_and_b32 v11, 15, v1
    s_lshl_b32 s22, s16, 5
    s_add_u32 s22, s22, s17
    v_add_u32 v11, s22, v11
    v_mul_lo_u32 v12, v11, s33
    v_lshrrev_b32 v13, 4, v1
    v_lshlrev_b32 v13, 4, v13
    v_add_u32 v12, v12, v13
    v_add_u32 v12, s18, v12
    v_add_u32 v12, s34, v12
    s_lshl_b32 s22, s33, 4
    v_add_u32 v13, s22, v12

    s_nop 1
    v_accvgpr_read_b32 v16, a0
    v_accvgpr_read_b32 v17, a1
    v_accvgpr_read_b32 v18, a2
    v_accvgpr_read_b32 v19, a3

    buffer_store_dwordx4 v[16:19], v12, s[12:15], 0 offen offset:0
    s_nop 1
    v_accvgpr_read_b32 v24, a4
    v_accvgpr_read_b32 v25, a5
    v_accvgpr_read_b32 v26, a6
    v_accvgpr_read_b32 v27, a7

    buffer_store_dwordx4 v[24:27], v12, s[12:15], 0 offen offset:64
    s_nop 1
    v_accvgpr_read_b32 v32, a8
    v_accvgpr_read_b32 v33, a9
    v_accvgpr_read_b32 v34, a10
    v_accvgpr_read_b32 v35, a11

    buffer_store_dwordx4 v[32:35], v12, s[12:15], 0 offen offset:128
    s_nop 1
    v_accvgpr_read_b32 v40, a12
    v_accvgpr_read_b32 v41, a13
    v_accvgpr_read_b32 v42, a14
    v_accvgpr_read_b32 v43, a15

    buffer_store_dwordx4 v[40:43], v12, s[12:15], 0 offen offset:192
    s_nop 1
    v_accvgpr_read_b32 v16, a16
    v_accvgpr_read_b32 v17, a17
    v_accvgpr_read_b32 v18, a18
    v_accvgpr_read_b32 v19, a19

    buffer_store_dwordx4 v[16:19], v12, s[12:15], 0 offen offset:256
    s_nop 1
    v_accvgpr_read_b32 v24, a20
    v_accvgpr_read_b32 v25, a21
    v_accvgpr_read_b32 v26, a22
    v_accvgpr_read_b32 v27, a23

    buffer_store_dwordx4 v[24:27], v12, s[12:15], 0 offen offset:320
    s_nop 1
    v_accvgpr_read_b32 v32, a24
    v_accvgpr_read_b32 v33, a25
    v_accvgpr_read_b32 v34, a26
    v_accvgpr_read_b32 v35, a27

    buffer_store_dwordx4 v[32:35], v12, s[12:15], 0 offen offset:384
    s_nop 1
    v_accvgpr_read_b32 v40, a28
    v_accvgpr_read_b32 v41, a29
    v_accvgpr_read_b32 v42, a30
    v_accvgpr_read_b32 v43, a31

    buffer_store_dwordx4 v[40:43], v12, s[12:15], 0 offen offset:448
    s_nop 1
    v_accvgpr_read_b32 v16, a32
    v_accvgpr_read_b32 v17, a33
    v_accvgpr_read_b32 v18, a34
    v_accvgpr_read_b32 v19, a35

    buffer_store_dwordx4 v[16:19], v12, s[12:15], 0 offen offset:512
    s_nop 1
    v_accvgpr_read_b32 v16, a36
    v_accvgpr_read_b32 v17, a37
    v_accvgpr_read_b32 v18, a38
    v_accvgpr_read_b32 v19, a39

    buffer_store_dwordx4 v[16:19], v13, s[12:15], 0 offen offset:0
    s_nop 1
    v_accvgpr_read_b32 v24, a40
    v_accvgpr_read_b32 v25, a41
    v_accvgpr_read_b32 v26, a42
    v_accvgpr_read_b32 v27, a43

    buffer_store_dwordx4 v[24:27], v13, s[12:15], 0 offen offset:64
    s_nop 1
    v_accvgpr_read_b32 v32, a44
    v_accvgpr_read_b32 v33, a45
    v_accvgpr_read_b32 v34, a46
    v_accvgpr_read_b32 v35, a47

    buffer_store_dwordx4 v[32:35], v13, s[12:15], 0 offen offset:128
    s_nop 1
    v_accvgpr_read_b32 v40, a48
    v_accvgpr_read_b32 v41, a49
    v_accvgpr_read_b32 v42, a50
    v_accvgpr_read_b32 v43, a51

    buffer_store_dwordx4 v[40:43], v13, s[12:15], 0 offen offset:192
    s_nop 1
    v_accvgpr_read_b32 v16, a52
    v_accvgpr_read_b32 v17, a53
    v_accvgpr_read_b32 v18, a54
    v_accvgpr_read_b32 v19, a55

    buffer_store_dwordx4 v[16:19], v13, s[12:15], 0 offen offset:256
    s_nop 1
    v_accvgpr_read_b32 v24, a56
    v_accvgpr_read_b32 v25, a57
    v_accvgpr_read_b32 v26, a58
    v_accvgpr_read_b32 v27, a59

    buffer_store_dwordx4 v[24:27], v13, s[12:15], 0 offen offset:320
    s_nop 1
    v_accvgpr_read_b32 v32, a60
    v_accvgpr_read_b32 v33, a61
    v_accvgpr_read_b32 v34, a62
    v_accvgpr_read_b32 v35, a63

    buffer_store_dwordx4 v[32:35], v13, s[12:15], 0 offen offset:384
    s_nop 1
    v_accvgpr_read_b32 v40, a64
    v_accvgpr_read_b32 v41, a65
    v_accvgpr_read_b32 v42, a66
    v_accvgpr_read_b32 v43, a67

    buffer_store_dwordx4 v[40:43], v13, s[12:15], 0 offen offset:448
    s_nop 1
    v_accvgpr_read_b32 v16, a68
    v_accvgpr_read_b32 v17, a69
    v_accvgpr_read_b32 v18, a70
    v_accvgpr_read_b32 v19, a71

    buffer_store_dwordx4 v[16:19], v13, s[12:15], 0 offen offset:512
    s_branch k2_done
k2_att:
    s_mov_b32 s8, s40
    s_mov_b32 s9, s41
    s_mov_b32 s10, 663552
    s_mov_b32 s11, 0x00020000
    s_mov_b32 s24, 33554432
    s_mov_b32 s25, 0
    v_lshrrev_b32 v11, 3, v1
    s_lshl_b32 s22, s16, 5
    s_add_u32 s22, s22, s17
    v_add_u32 v12, s22, v11
    s_mov_b32 s23, 1152
    v_mul_lo_u32 v2, v12, s23
    v_lshrrev_b32 v12, 1, v11
    v_and_b32 v12, 7, v12
    v_and_b32 v13, 7, v1
    v_xor_b32 v12, v12, v13
    v_lshlrev_b32 v12, 4, v12
    v_xor_b32 v13, 64, v12
    v_add_u32 v105, v2, v13
    v_add_u32 v2, v2, v12
    v_and_b32 v11, 15, v1
    v_lshrrev_b32 v12, 4, v1
    v_lshrrev_b32 v13, 1, v11
    v_and_b32 v13, 7, v13
    v_xor_b32 v14, v12, v13
    v_lshlrev_b32 v14, 4, v14
    v_xor_b32 v15, 4, v12
    v_xor_b32 v15, v15, v13
    v_lshlrev_b32 v15, 4, v15
    s_lshl_b32 s22, s16, 12
    v_lshlrev_b32 v11, 7, v11
    v_add_u32 v11, s22, v11
    v_add_u32 v11, 36864, v11
    v_add_u32 v3, v11, v14
    v_add_u32 v104, v11, v15

    s_mul_i32 s22, s16, 288
    s_add_u32 s22, s22, 0
    v_add_u32 v11, s22, v1
    s_movk_i32 s23, 3641
    v_mul_lo_u32 v12, v11, s23
    v_lshrrev_b32 v12, 16, v12
    v_mul_u32_u24 v13, 18, v12
    v_sub_u32 v13, v11, v13
    v_lshrrev_b32 v14, 3, v12
    v_and_b32 v14, 1, v14
    v_lshlrev_b32 v14, 2, v14
    v_xor_b32 v12, v12, v14
    s_mov_b32 s23, 1152
    v_mul_lo_u32 v12, v12, s23
    v_lshlrev_b32 v14, 4, v13
    v_add_u32 v12, v12, v14

    v_add_u32 v4, s18, v12
    s_mul_i32 s22, s16, 288
    s_add_u32 s22, s22, 64
    v_add_u32 v11, s22, v1
    s_movk_i32 s23, 3641
    v_mul_lo_u32 v12, v11, s23
    v_lshrrev_b32 v12, 16, v12
    v_mul_u32_u24 v13, 18, v12
    v_sub_u32 v13, v11, v13
    v_lshrrev_b32 v14, 3, v12
    v_and_b32 v14, 1, v14
    v_lshlrev_b32 v14, 2, v14
    v_xor_b32 v12, v12, v14
    s_mov_b32 s23, 1152
    v_mul_lo_u32 v12, v12, s23
    v_lshlrev_b32 v14, 4, v13
    v_add_u32 v12, v12, v14

    v_add_u32 v5, s18, v12
    s_mul_i32 s22, s16, 288
    s_add_u32 s22, s22, 128
    v_add_u32 v11, s22, v1
    s_movk_i32 s23, 3641
    v_mul_lo_u32 v12, v11, s23
    v_lshrrev_b32 v12, 16, v12
    v_mul_u32_u24 v13, 18, v12
    v_sub_u32 v13, v11, v13
    v_lshrrev_b32 v14, 3, v12
    v_and_b32 v14, 1, v14
    v_lshlrev_b32 v14, 2, v14
    v_xor_b32 v12, v12, v14
    s_mov_b32 s23, 1152
    v_mul_lo_u32 v12, v12, s23
    v_lshlrev_b32 v14, 4, v13
    v_add_u32 v12, v12, v14

    v_add_u32 v6, s18, v12
    s_mul_i32 s22, s16, 288
    s_add_u32 s22, s22, 192
    v_add_u32 v11, s22, v1
    s_movk_i32 s23, 3641
    v_mul_lo_u32 v12, v11, s23
    v_lshrrev_b32 v12, 16, v12
    v_mul_u32_u24 v13, 18, v12
    v_sub_u32 v13, v11, v13
    v_lshrrev_b32 v14, 3, v12
    v_and_b32 v14, 1, v14
    v_lshlrev_b32 v14, 2, v14
    v_xor_b32 v12, v12, v14
    s_mov_b32 s23, 1152
    v_mul_lo_u32 v12, v12, s23
    v_lshlrev_b32 v14, 4, v13
    v_add_u32 v12, v12, v14

    v_add_u32 v7, s18, v12
    s_mul_i32 s22, s16, 288
    s_add_u32 s22, s22, 256
    v_add_u32 v11, s22, v1
    s_movk_i32 s23, 3641
    v_mul_lo_u32 v12, v11, s23
    v_lshrrev_b32 v12, 16, v12
    v_mul_u32_u24 v13, 18, v12
    v_sub_u32 v13, v11, v13
    v_lshrrev_b32 v14, 3, v12
    v_and_b32 v14, 1, v14
    v_lshlrev_b32 v14, 2, v14
    v_xor_b32 v12, v12, v14
    s_mov_b32 s23, 1152
    v_mul_lo_u32 v12, v12, s23
    v_lshlrev_b32 v14, 4, v13
    v_add_u32 v12, v12, v14

    v_add_u32 v8, s18, v12
    v_lshrrev_b32 v11, 4, v1
    v_and_b32 v12, 15, v1
    v_lshrrev_b32 v13, 2, v12
    v_and_b32 v14, 3, v12
    v_and_b32 v15, 1, v11
    v_lshlrev_b32 v15, 2, v15
    v_lshlrev_b32 v11, 3, v11
    v_add_u32 v11, v11, v13
    v_add_u32 v12, v11, v15
    v_mul_u32_u24 v12, 288, v12
    v_lshlrev_b32 v14, 3, v14
    v_add_u32 v9, v12, v14
    v_xor_b32 v15, 4, v15
    v_add_u32 v12, v11, v15
    v_mul_u32_u24 v12, 288, v12
    v_add_u32 v10, v12, v14

    v_accvgpr_write_b32 a0, 0
    v_accvgpr_write_b32 a1, 0
    v_accvgpr_write_b32 a2, 0
    v_accvgpr_write_b32 a3, 0
    v_accvgpr_write_b32 a4, 0
    v_accvgpr_write_b32 a5, 0
    v_accvgpr_write_b32 a6, 0
    v_accvgpr_write_b32 a7, 0
    v_accvgpr_write_b32 a8, 0
    v_accvgpr_write_b32 a9, 0
    v_accvgpr_write_b32 a10, 0
    v_accvgpr_write_b32 a11, 0
    v_accvgpr_write_b32 a12, 0
    v_accvgpr_write_b32 a13, 0
    v_accvgpr_write_b32 a14, 0
    v_accvgpr_write_b32 a15, 0
    v_accvgpr_write_b32 a16, 0
    v_accvgpr_write_b32 a17, 0
    v_accvgpr_write_b32 a18, 0
    v_accvgpr_write_b32 a19, 0
    v_accvgpr_write_b32 a20, 0
    v_accvgpr_write_b32 a21, 0
    v_accvgpr_write_b32 a22, 0
    v_accvgpr_write_b32 a23, 0
    v_accvgpr_write_b32 a24, 0
    v_accvgpr_write_b32 a25, 0
    v_accvgpr_write_b32 a26, 0
    v_accvgpr_write_b32 a27, 0
    v_accvgpr_write_b32 a28, 0
    v_accvgpr_write_b32 a29, 0
    v_accvgpr_write_b32 a30, 0
    v_accvgpr_write_b32 a31, 0
    v_accvgpr_write_b32 a32, 0
    v_accvgpr_write_b32 a33, 0
    v_accvgpr_write_b32 a34, 0
    v_accvgpr_write_b32 a35, 0
    v_accvgpr_write_b32 a36, 0
    v_accvgpr_write_b32 a37, 0
    v_accvgpr_write_b32 a38, 0
    v_accvgpr_write_b32 a39, 0
    v_accvgpr_write_b32 a40, 0
    v_accvgpr_write_b32 a41, 0
    v_accvgpr_write_b32 a42, 0
    v_accvgpr_write_b32 a43, 0
    v_accvgpr_write_b32 a44, 0
    v_accvgpr_write_b32 a45, 0
    v_accvgpr_write_b32 a46, 0
    v_accvgpr_write_b32 a47, 0
    v_accvgpr_write_b32 a48, 0
    v_accvgpr_write_b32 a49, 0
    v_accvgpr_write_b32 a50, 0
    v_accvgpr_write_b32 a51, 0
    v_accvgpr_write_b32 a52, 0
    v_accvgpr_write_b32 a53, 0
    v_accvgpr_write_b32 a54, 0
    v_accvgpr_write_b32 a55, 0
    v_accvgpr_write_b32 a56, 0
    v_accvgpr_write_b32 a57, 0
    v_accvgpr_write_b32 a58, 0
    v_accvgpr_write_b32 a59, 0
    v_accvgpr_write_b32 a60, 0
    v_accvgpr_write_b32 a61, 0
    v_accvgpr_write_b32 a62, 0
    v_accvgpr_write_b32 a63, 0
    v_accvgpr_write_b32 a64, 0
    v_accvgpr_write_b32 a65, 0
    v_accvgpr_write_b32 a66, 0
    v_accvgpr_write_b32 a67, 0
    v_accvgpr_write_b32 a68, 0
    v_accvgpr_write_b32 a69, 0
    v_accvgpr_write_b32 a70, 0
    v_accvgpr_write_b32 a71, 0
    s_mul_i32 s26, s16, 4608
    s_lshl_b32 s31, s16, 12
    s_mov_b32 s29, 0x7ffffff0
    s_mov_b32 s28, 9
    s_mov_b32 s30, 9

    s_cmp_gt_i32 s28, 0
    s_cselect_b32 s22, s25, s29
    s_cselect_b32 s23, s24, s29
    s_add_u32 m0, s31, 36864
    s_add_u32 s27, s23, 0
    buffer_load_dwordx4 v2, s[4:7], s27 offen lds
    s_add_u32 m0, s31, 37888
    s_add_u32 s27, s23, 9216
    buffer_load_dwordx4 v105, s[4:7], s27 offen lds
    s_add_u32 m0, s31, 38912
    s_add_u32 s27, s23, 18432
    buffer_load_dwordx4 v2, s[4:7], s27 offen lds
    s_add_u32 m0, s31, 39936
    s_add_u32 s27, s23, 27648
    buffer_load_dwordx4 v105, s[4:7], s27 offen lds
    s_add_u32 m0, s26, 0
    s_nop 0
    buffer_load_dwordx4 v4, s[8:11], s22 offen lds
    s_add_u32 m0, s26, 1024
    s_nop 0
    buffer_load_dwordx4 v5, s[8:11], s22 offen lds
    s_add_u32 m0, s26, 2048
    s_nop 0
    buffer_load_dwordx4 v6, s[8:11], s22 offen lds
    s_add_u32 m0, s26, 3072
    s_nop 0
    buffer_load_dwordx4 v7, s[8:11], s22 offen lds
    s_add_u32 m0, s26, 4096
    s_mov_b64 exec, 0xffffffff
    buffer_load_dwordx4 v8, s[8:11], s22 offen lds
    s_mov_b64 exec, -1
    s_add_u32 s25, s25, 73728
    s_add_u32 s24, s24, 128
    s_sub_u32 s28, s28, 1
Lloop_9:
    s_waitcnt vmcnt(0)
    s_barrier
    s_cmp_gt_i32 s28, 0
    s_cselect_b32 s22, s25, s29
    s_cselect_b32 s23, s24, s29
    s_add_u32 m0, s31, 53248
    s_add_u32 s27, s23, 0
    buffer_load_dwordx4 v2, s[4:7], s27 offen lds
    s_add_u32 m0, s31, 54272
    s_add_u32 s27, s23, 9216
    buffer_load_dwordx4 v105, s[4:7], s27 offen lds
    s_add_u32 m0, s31, 55296
    s_add_u32 s27, s23, 18432
    buffer_load_dwordx4 v2, s[4:7], s27 offen lds
    s_add_u32 m0, s31, 56320
    s_add_u32 s27, s23, 27648
    buffer_load_dwordx4 v105, s[4:7], s27 offen lds
    s_add_u32 m0, s26, 18432
    s_nop 0
    buffer_load_dwordx4 v4, s[8:11], s22 offen lds
    s_add_u32 m0, s26, 19456
    s_nop 0
    buffer_load_dwordx4 v5, s[8:11], s22 offen lds
    s_add_u32 m0, s26, 20480
    s_nop 0
    buffer_load_dwordx4 v6, s[8:11], s22 offen lds
    s_add_u32 m0, s26, 21504
    s_nop 0
    buffer_load_dwordx4 v7, s[8:11], s22 offen lds
    s_add_u32 m0, s26, 22528
    s_mov_b64 exec, 0xffffffff
    buffer_load_dwordx4 v8, s[8:11], s22 offen lds
    s_mov_b64 exec, -1
    s_add_u32 s25, s25, 73728
    s_add_u32 s24, s24, 128
    s_sub_u32 s28, s28, 1
    ds_read_b128 v[16:19], v3 offset:0
    ds_read_b128 v[20:23], v104 offset:0
    ds_read_b128 v[24:27], v3 offset:2048
    ds_read_b128 v[28:31], v104 offset:2048
    ds_read_b64_tr_b16 v[80:81], v9 offset:0
    ds_read_b64_tr_b16 v[82:83], v10 offset:0
    ds_read_b64_tr_b16 v[84:85], v9 offset:32
    ds_read_b64_tr_b16 v[86:87], v10 offset:32
    ds_read_b64_tr_b16 v[88:89], v9 offset:64
    ds_read_b64_tr_b16 v[90:91], v10 offset:64
    ds_read_b64_tr_b16 v[92:93], v9 offset:96
    ds_read_b64_tr_b16 v[94:95], v10 offset:96
    ds_read_b64_tr_b16 v[96:97], v9 offset:128
    ds_read_b64_tr_b16 v[98:99], v10 offset:128
    s_waitcnt lgkmcnt(8)
    v_mfma_f32_16x16x32_bf16 a[0:3], v[80:83], v[16:19], a[0:3]
    v_mfma_f32_16x16x32_bf16 a[36:39], v[80:83], v[24:27], a[36:39]
    ds_read_b64_tr_b16 v[100:101], v9 offset:160
    ds_read_b64_tr_b16 v[102:103], v10 offset:160
    s_waitcnt lgkmcnt(8)
    v_mfma_f32_16x16x32_bf16 a[4:7], v[84:87], v[16:19], a[4:7]
    v_mfma_f32_16x16x32_bf16 a[40:43], v[84:87], v[24:27], a[40:43]
    ds_read_b64_tr_b16 v[80:81], v9 offset:192
    ds_read_b64_tr_b16 v[82:83], v10 offset:192
    s_waitcnt lgkmcnt(8)
    v_mfma_f32_16x16x32_bf16 a[8:11], v[88:91], v[16:19], a[8:11]
    v_mfma_f32_16x16x32_bf16 a[44:47], v[88:91], v[24:27], a[44:47]
    ds_read_b64_tr_b16 v[84:85], v9 offset:224
    ds_read_b64_tr_b16 v[86:87], v10 offset:224
    s_waitcnt lgkmcnt(8)
    v_mfma_f32_16x16x32_bf16 a[12:15], v[92:95], v[16:19], a[12:15]
    v_mfma_f32_16x16x32_bf16 a[48:51], v[92:95], v[24:27], a[48:51]
    ds_read_b64_tr_b16 v[88:89], v9 offset:256
    ds_read_b64_tr_b16 v[90:91], v10 offset:256
    s_waitcnt lgkmcnt(8)
    v_mfma_f32_16x16x32_bf16 a[16:19], v[96:99], v[16:19], a[16:19]
    v_mfma_f32_16x16x32_bf16 a[52:55], v[96:99], v[24:27], a[52:55]
    ds_read_b64_tr_b16 v[92:93], v9 offset:9216
    ds_read_b64_tr_b16 v[94:95], v10 offset:9216
    s_waitcnt lgkmcnt(8)
    v_mfma_f32_16x16x32_bf16 a[20:23], v[100:103], v[16:19], a[20:23]
    v_mfma_f32_16x16x32_bf16 a[56:59], v[100:103], v[24:27], a[56:59]
    ds_read_b64_tr_b16 v[96:97], v9 offset:9248
    ds_read_b64_tr_b16 v[98:99], v10 offset:9248
    s_waitcnt lgkmcnt(8)
    v_mfma_f32_16x16x32_bf16 a[24:27], v[80:83], v[16:19], a[24:27]
    v_mfma_f32_16x16x32_bf16 a[60:63], v[80:83], v[24:27], a[60:63]
    ds_read_b64_tr_b16 v[100:101], v9 offset:9280
    ds_read_b64_tr_b16 v[102:103], v10 offset:9280
    s_waitcnt lgkmcnt(8)
    v_mfma_f32_16x16x32_bf16 a[28:31], v[84:87], v[16:19], a[28:31]
    v_mfma_f32_16x16x32_bf16 a[64:67], v[84:87], v[24:27], a[64:67]
    ds_read_b64_tr_b16 v[80:81], v9 offset:9312
    ds_read_b64_tr_b16 v[82:83], v10 offset:9312
    s_waitcnt lgkmcnt(8)
    v_mfma_f32_16x16x32_bf16 a[32:35], v[88:91], v[16:19], a[32:35]
    v_mfma_f32_16x16x32_bf16 a[68:71], v[88:91], v[24:27], a[68:71]
    ds_read_b64_tr_b16 v[84:85], v9 offset:9344
    ds_read_b64_tr_b16 v[86:87], v10 offset:9344
    s_waitcnt lgkmcnt(8)
    v_mfma_f32_16x16x32_bf16 a[0:3], v[92:95], v[20:23], a[0:3]
    v_mfma_f32_16x16x32_bf16 a[36:39], v[92:95], v[28:31], a[36:39]
    ds_read_b64_tr_b16 v[88:89], v9 offset:9376
    ds_read_b64_tr_b16 v[90:91], v10 offset:9376
    s_waitcnt lgkmcnt(8)
    v_mfma_f32_16x16x32_bf16 a[4:7], v[96:99], v[20:23], a[4:7]
    v_mfma_f32_16x16x32_bf16 a[40:43], v[96:99], v[28:31], a[40:43]
    ds_read_b64_tr_b16 v[92:93], v9 offset:9408
    ds_read_b64_tr_b16 v[94:95], v10 offset:9408
    s_waitcnt lgkmcnt(8)
    v_mfma_f32_16x16x32_bf16 a[8:11], v[100:103], v[20:23], a[8:11]
    v_mfma_f32_16x16x32_bf16 a[44:47], v[100:103], v[28:31], a[44:47]
    ds_read_b64_tr_b16 v[96:97], v9 offset:9440
    ds_read_b64_tr_b16 v[98:99], v10 offset:9440
    s_waitcnt lgkmcnt(8)
    v_mfma_f32_16x16x32_bf16 a[12:15], v[80:83], v[20:23], a[12:15]
    v_mfma_f32_16x16x32_bf16 a[48:51], v[80:83], v[28:31], a[48:51]
    ds_read_b64_tr_b16 v[100:101], v9 offset:9472
    ds_read_b64_tr_b16 v[102:103], v10 offset:9472
    s_waitcnt lgkmcnt(8)
    v_mfma_f32_16x16x32_bf16 a[16:19], v[84:87], v[20:23], a[16:19]
    v_mfma_f32_16x16x32_bf16 a[52:55], v[84:87], v[28:31], a[52:55]
    s_waitcnt lgkmcnt(6)
    v_mfma_f32_16x16x32_bf16 a[20:23], v[88:91], v[20:23], a[20:23]
    v_mfma_f32_16x16x32_bf16 a[56:59], v[88:91], v[28:31], a[56:59]
    s_waitcnt lgkmcnt(4)
    v_mfma_f32_16x16x32_bf16 a[24:27], v[92:95], v[20:23], a[24:27]
    v_mfma_f32_16x16x32_bf16 a[60:63], v[92:95], v[28:31], a[60:63]
    s_waitcnt lgkmcnt(2)
    v_mfma_f32_16x16x32_bf16 a[28:31], v[96:99], v[20:23], a[28:31]
    v_mfma_f32_16x16x32_bf16 a[64:67], v[96:99], v[28:31], a[64:67]
    s_waitcnt lgkmcnt(0)
    v_mfma_f32_16x16x32_bf16 a[32:35], v[100:103], v[20:23], a[32:35]
    v_mfma_f32_16x16x32_bf16 a[68:71], v[100:103], v[28:31], a[68:71]
    s_sub_u32 s30, s30, 1
    s_cmp_eq_u32 s30, 0
    s_cbranch_scc1 Lend_10
    s_waitcnt vmcnt(0)
    s_barrier
    s_cmp_gt_i32 s28, 0
    s_cselect_b32 s22, s25, s29
    s_cselect_b32 s23, s24, s29
    s_add_u32 m0, s31, 36864
    s_add_u32 s27, s23, 0
    buffer_load_dwordx4 v2, s[4:7], s27 offen lds
    s_add_u32 m0, s31, 37888
    s_add_u32 s27, s23, 9216
    buffer_load_dwordx4 v105, s[4:7], s27 offen lds
    s_add_u32 m0, s31, 38912
    s_add_u32 s27, s23, 18432
    buffer_load_dwordx4 v2, s[4:7], s27 offen lds
    s_add_u32 m0, s31, 39936
    s_add_u32 s27, s23, 27648
    buffer_load_dwordx4 v105, s[4:7], s27 offen lds
    s_add_u32 m0, s26, 0
    s_nop 0
    buffer_load_dwordx4 v4, s[8:11], s22 offen lds
    s_add_u32 m0, s26, 1024
    s_nop 0
    buffer_load_dwordx4 v5, s[8:11], s22 offen lds
    s_add_u32 m0, s26, 2048
    s_nop 0
    buffer_load_dwordx4 v6, s[8:11], s22 offen lds
    s_add_u32 m0, s26, 3072
    s_nop 0
    buffer_load_dwordx4 v7, s[8:11], s22 offen lds
    s_add_u32 m0, s26, 4096
    s_mov_b64 exec, 0xffffffff
    buffer_load_dwordx4 v8, s[8:11], s22 offen lds
    s_mov_b64 exec, -1
    s_add_u32 s25, s25, 73728
    s_add_u32 s24, s24, 128
    s_sub_u32 s28, s28, 1
    ds_read_b128 v[16:19], v3 offset:16384
    ds_read_b128 v[20:23], v104 offset:16384
    ds_read_b128 v[24:27], v3 offset:18432
    ds_read_b128 v[28:31], v104 offset:18432
    ds_read_b64_tr_b16 v[80:81], v9 offset:18432
    ds_read_b64_tr_b16 v[82:83], v10 offset:18432
    ds_read_b64_tr_b16 v[84:85], v9 offset:18464
    ds_read_b64_tr_b16 v[86:87], v10 offset:18464
    ds_read_b64_tr_b16 v[88:89], v9 offset:18496
    ds_read_b64_tr_b16 v[90:91], v10 offset:18496
    ds_read_b64_tr_b16 v[92:93], v9 offset:18528
    ds_read_b64_tr_b16 v[94:95], v10 offset:18528
    ds_read_b64_tr_b16 v[96:97], v9 offset:18560
    ds_read_b64_tr_b16 v[98:99], v10 offset:18560
    s_waitcnt lgkmcnt(8)
    v_mfma_f32_16x16x32_bf16 a[0:3], v[80:83], v[16:19], a[0:3]
    v_mfma_f32_16x16x32_bf16 a[36:39], v[80:83], v[24:27], a[36:39]
    ds_read_b64_tr_b16 v[100:101], v9 offset:18592
    ds_read_b64_tr_b16 v[102:103], v10 offset:18592
    s_waitcnt lgkmcnt(8)
    v_mfma_f32_16x16x32_bf16 a[4:7], v[84:87], v[16:19], a[4:7]
    v_mfma_f32_16x16x32_bf16 a[40:43], v[84:87], v[24:27], a[40:43]
    ds_read_b64_tr_b16 v[80:81], v9 offset:18624
    ds_read_b64_tr_b16 v[82:83], v10 offset:18624
    s_waitcnt lgkmcnt(8)
    v_mfma_f32_16x16x32_bf16 a[8:11], v[88:91], v[16:19], a[8:11]
    v_mfma_f32_16x16x32_bf16 a[44:47], v[88:91], v[24:27], a[44:47]
    ds_read_b64_tr_b16 v[84:85], v9 offset:18656
    ds_read_b64_tr_b16 v[86:87], v10 offset:18656
    s_waitcnt lgkmcnt(8)
    v_mfma_f32_16x16x32_bf16 a[12:15], v[92:95], v[16:19], a[12:15]
    v_mfma_f32_16x16x32_bf16 a[48:51], v[92:95], v[24:27], a[48:51]
    ds_read_b64_tr_b16 v[88:89], v9 offset:18688
    ds_read_b64_tr_b16 v[90:91], v10 offset:18688
    s_waitcnt lgkmcnt(8)
    v_mfma_f32_16x16x32_bf16 a[16:19], v[96:99], v[16:19], a[16:19]
    v_mfma_f32_16x16x32_bf16 a[52:55], v[96:99], v[24:27], a[52:55]
    ds_read_b64_tr_b16 v[92:93], v9 offset:27648
    ds_read_b64_tr_b16 v[94:95], v10 offset:27648
    s_waitcnt lgkmcnt(8)
    v_mfma_f32_16x16x32_bf16 a[20:23], v[100:103], v[16:19], a[20:23]
    v_mfma_f32_16x16x32_bf16 a[56:59], v[100:103], v[24:27], a[56:59]
    ds_read_b64_tr_b16 v[96:97], v9 offset:27680
    ds_read_b64_tr_b16 v[98:99], v10 offset:27680
    s_waitcnt lgkmcnt(8)
    v_mfma_f32_16x16x32_bf16 a[24:27], v[80:83], v[16:19], a[24:27]
    v_mfma_f32_16x16x32_bf16 a[60:63], v[80:83], v[24:27], a[60:63]
    ds_read_b64_tr_b16 v[100:101], v9 offset:27712
    ds_read_b64_tr_b16 v[102:103], v10 offset:27712
    s_waitcnt lgkmcnt(8)
    v_mfma_f32_16x16x32_bf16 a[28:31], v[84:87], v[16:19], a[28:31]
    v_mfma_f32_16x16x32_bf16 a[64:67], v[84:87], v[24:27], a[64:67]
    ds_read_b64_tr_b16 v[80:81], v9 offset:27744
    ds_read_b64_tr_b16 v[82:83], v10 offset:27744
    s_waitcnt lgkmcnt(8)
    v_mfma_f32_16x16x32_bf16 a[32:35], v[88:91], v[16:19], a[32:35]
    v_mfma_f32_16x16x32_bf16 a[68:71], v[88:91], v[24:27], a[68:71]
    ds_read_b64_tr_b16 v[84:85], v9 offset:27776
    ds_read_b64_tr_b16 v[86:87], v10 offset:27776
    s_waitcnt lgkmcnt(8)
    v_mfma_f32_16x16x32_bf16 a[0:3], v[92:95], v[20:23], a[0:3]
    v_mfma_f32_16x16x32_bf16 a[36:39], v[92:95], v[28:31], a[36:39]
    ds_read_b64_tr_b16 v[88:89], v9 offset:27808
    ds_read_b64_tr_b16 v[90:91], v10 offset:27808
    s_waitcnt lgkmcnt(8)
    v_mfma_f32_16x16x32_bf16 a[4:7], v[96:99], v[20:23], a[4:7]
    v_mfma_f32_16x16x32_bf16 a[40:43], v[96:99], v[28:31], a[40:43]
    ds_read_b64_tr_b16 v[92:93], v9 offset:27840
    ds_read_b64_tr_b16 v[94:95], v10 offset:27840
    s_waitcnt lgkmcnt(8)
    v_mfma_f32_16x16x32_bf16 a[8:11], v[100:103], v[20:23], a[8:11]
    v_mfma_f32_16x16x32_bf16 a[44:47], v[100:103], v[28:31], a[44:47]
    ds_read_b64_tr_b16 v[96:97], v9 offset:27872
    ds_read_b64_tr_b16 v[98:99], v10 offset:27872
    s_waitcnt lgkmcnt(8)
    v_mfma_f32_16x16x32_bf16 a[12:15], v[80:83], v[20:23], a[12:15]
    v_mfma_f32_16x16x32_bf16 a[48:51], v[80:83], v[28:31], a[48:51]
    ds_read_b64_tr_b16 v[100:101], v9 offset:27904
    ds_read_b64_tr_b16 v[102:103], v10 offset:27904
    s_waitcnt lgkmcnt(8)
    v_mfma_f32_16x16x32_bf16 a[16:19], v[84:87], v[20:23], a[16:19]
    v_mfma_f32_16x16x32_bf16 a[52:55], v[84:87], v[28:31], a[52:55]
    s_waitcnt lgkmcnt(6)
    v_mfma_f32_16x16x32_bf16 a[20:23], v[88:91], v[20:23], a[20:23]
    v_mfma_f32_16x16x32_bf16 a[56:59], v[88:91], v[28:31], a[56:59]
    s_waitcnt lgkmcnt(4)
    v_mfma_f32_16x16x32_bf16 a[24:27], v[92:95], v[20:23], a[24:27]
    v_mfma_f32_16x16x32_bf16 a[60:63], v[92:95], v[28:31], a[60:63]
    s_waitcnt lgkmcnt(2)
    v_mfma_f32_16x16x32_bf16 a[28:31], v[96:99], v[20:23], a[28:31]
    v_mfma_f32_16x16x32_bf16 a[64:67], v[96:99], v[28:31], a[64:67]
    s_waitcnt lgkmcnt(0)
    v_mfma_f32_16x16x32_bf16 a[32:35], v[100:103], v[20:23], a[32:35]
    v_mfma_f32_16x16x32_bf16 a[68:71], v[100:103], v[28:31], a[68:71]
    s_sub_u32 s30, s30, 1
    s_cmp_eq_u32 s30, 0
    s_cbranch_scc0 Lloop_9
Lend_10:
    s_waitcnt vmcnt(0)
    s_lshl_b32 s18, s18, 1
    s_nop 7
    s_nop 7
    v_and_b32 v11, 15, v1
    s_lshl_b32 s22, s16, 5
    s_add_u32 s22, s22, s17
    v_add_u32 v11, s22, v11
    v_mul_lo_u32 v12, v11, s33
    v_lshrrev_b32 v13, 4, v1
    v_lshlrev_b32 v13, 4, v13
    v_add_u32 v12, v12, v13
    v_add_u32 v12, s18, v12
    v_add_u32 v12, s34, v12
    s_lshl_b32 s22, s33, 4
    v_add_u32 v13, s22, v12

    s_nop 1
    v_accvgpr_read_b32 v16, a0
    v_accvgpr_read_b32 v17, a1
    v_accvgpr_read_b32 v18, a2
    v_accvgpr_read_b32 v19, a3

    buffer_store_dwordx4 v[16:19], v12, s[12:15], 0 offen offset:0
    s_nop 1
    v_accvgpr_read_b32 v24, a4
    v_accvgpr_read_b32 v25, a5
    v_accvgpr_read_b32 v26, a6
    v_accvgpr_read_b32 v27, a7

    buffer_store_dwordx4 v[24:27], v12, s[12:15], 0 offen offset:64
    s_nop 1
    v_accvgpr_read_b32 v32, a8
    v_accvgpr_read_b32 v33, a9
    v_accvgpr_read_b32 v34, a10
    v_accvgpr_read_b32 v35, a11

    buffer_store_dwordx4 v[32:35], v12, s[12:15], 0 offen offset:128
    s_nop 1
    v_accvgpr_read_b32 v40, a12
    v_accvgpr_read_b32 v41, a13
    v_accvgpr_read_b32 v42, a14
    v_accvgpr_read_b32 v43, a15

    buffer_store_dwordx4 v[40:43], v12, s[12:15], 0 offen offset:192
    s_nop 1
    v_accvgpr_read_b32 v16, a16
    v_accvgpr_read_b32 v17, a17
    v_accvgpr_read_b32 v18, a18
    v_accvgpr_read_b32 v19, a19

    buffer_store_dwordx4 v[16:19], v12, s[12:15], 0 offen offset:256
    s_nop 1
    v_accvgpr_read_b32 v24, a20
    v_accvgpr_read_b32 v25, a21
    v_accvgpr_read_b32 v26, a22
    v_accvgpr_read_b32 v27, a23

    buffer_store_dwordx4 v[24:27], v12, s[12:15], 0 offen offset:320
    s_nop 1
    v_accvgpr_read_b32 v32, a24
    v_accvgpr_read_b32 v33, a25
    v_accvgpr_read_b32 v34, a26
    v_accvgpr_read_b32 v35, a27

    buffer_store_dwordx4 v[32:35], v12, s[12:15], 0 offen offset:384
    s_nop 1
    v_accvgpr_read_b32 v40, a28
    v_accvgpr_read_b32 v41, a29
    v_accvgpr_read_b32 v42, a30
    v_accvgpr_read_b32 v43, a31

    buffer_store_dwordx4 v[40:43], v12, s[12:15], 0 offen offset:448
    s_nop 1
    v_accvgpr_read_b32 v16, a32
    v_accvgpr_read_b32 v17, a33
    v_accvgpr_read_b32 v18, a34
    v_accvgpr_read_b32 v19, a35

    buffer_store_dwordx4 v[16:19], v12, s[12:15], 0 offen offset:512
    s_nop 1
    v_accvgpr_read_b32 v16, a36
    v_accvgpr_read_b32 v17, a37
    v_accvgpr_read_b32 v18, a38
    v_accvgpr_read_b32 v19, a39

    buffer_store_dwordx4 v[16:19], v13, s[12:15], 0 offen offset:0
    s_nop 1
    v_accvgpr_read_b32 v24, a40
    v_accvgpr_read_b32 v25, a41
    v_accvgpr_read_b32 v26, a42
    v_accvgpr_read_b32 v27, a43

    buffer_store_dwordx4 v[24:27], v13, s[12:15], 0 offen offset:64
    s_nop 1
    v_accvgpr_read_b32 v32, a44
    v_accvgpr_read_b32 v33, a45
    v_accvgpr_read_b32 v34, a46
    v_accvgpr_read_b32 v35, a47

    buffer_store_dwordx4 v[32:35], v13, s[12:15], 0 offen offset:128
    s_nop 1
    v_accvgpr_read_b32 v40, a48
    v_accvgpr_read_b32 v41, a49
    v_accvgpr_read_b32 v42, a50
    v_accvgpr_read_b32 v43, a51

    buffer_store_dwordx4 v[40:43], v13, s[12:15], 0 offen offset:192
    s_nop 1
    v_accvgpr_read_b32 v16, a52
    v_accvgpr_read_b32 v17, a53
    v_accvgpr_read_b32 v18, a54
    v_accvgpr_read_b32 v19, a55

    buffer_store_dwordx4 v[16:19], v13, s[12:15], 0 offen offset:256
    s_nop 1
    v_accvgpr_read_b32 v24, a56
    v_accvgpr_read_b32 v25, a57
    v_accvgpr_read_b32 v26, a58
    v_accvgpr_read_b32 v27, a59

    buffer_store_dwordx4 v[24:27], v13, s[12:15], 0 offen offset:320
    s_nop 1
    v_accvgpr_read_b32 v32, a60
    v_accvgpr_read_b32 v33, a61
    v_accvgpr_read_b32 v34, a62
    v_accvgpr_read_b32 v35, a63

    buffer_store_dwordx4 v[32:35], v13, s[12:15], 0 offen offset:384
    s_nop 1
    v_accvgpr_read_b32 v40, a64
    v_accvgpr_read_b32 v41, a65
    v_accvgpr_read_b32 v42, a66
    v_accvgpr_read_b32 v43, a67

    buffer_store_dwordx4 v[40:43], v13, s[12:15], 0 offen offset:448
    s_nop 1
    v_accvgpr_read_b32 v16, a68
    v_accvgpr_read_b32 v17, a69
    v_accvgpr_read_b32 v18, a70
    v_accvgpr_read_b32 v19, a71

    buffer_store_dwordx4 v[16:19], v13, s[12:15], 0 offen offset:512
k2_done:
    s_endpgm
.globl kfin_kernel
.p2align 8
.type kfin_kernel,@function
kfin_kernel:
    s_load_dwordx2 s[40:41], s[0:1], 0
    s_load_dwordx2 s[42:43], s[0:1], 48
    s_load_dwordx2 s[44:45], s[0:1], 56
    s_load_dwordx2 s[46:47], s[0:1], 72
    s_cmp_ge_u32 s2, 512
    s_cbranch_scc1 kfin_done
    v_lshrrev_b32 v2, 6, v0
    v_and_b32 v1, 63, v0
    s_nop 0
    v_readfirstlane_b32 s16, v2
    s_lshl_b32 s4, s2, 2
    s_add_u32 s4, s4, s16
    s_waitcnt lgkmcnt(0)

    s_mov_b32 s8, s40
    s_mov_b32 s9, s41
    s_mov_b32 s10, 2359296
    s_mov_b32 s11, 0x00020000
    s_mov_b32 s20, s42
    s_mov_b32 s21, s43
    s_mov_b32 s22, 1152
    s_mov_b32 s23, 0x00020000
    s_mov_b32 s24, s44
    s_mov_b32 s25, s45
    s_mov_b32 s26, 2359296
    s_mov_b32 s27, 0x00020000
    s_mov_b32 s12, s46
    s_mov_b32 s13, s47
    s_mov_b32 s14, 268435456
    s_mov_b32 s15, 0x00020000
    v_lshlrev_b32 v3, 1, v1
    s_mul_i32 s5, s4, 1152
    s_mul_i32 s6, s4, 2304
    s_add_u32 s6, s6, 50331648
    v_lshlrev_b32 v4, 2, v1
    v_mov_b32 v5, 0

    buffer_load_ushort v16, v3, s[8:11], s5 offen offset:0
    buffer_load_ushort v32, v3, s[20:23], 0 offen offset:0
    buffer_load_ushort v17, v3, s[8:11], s5 offen offset:128
    buffer_load_ushort v33, v3, s[20:23], 0 offen offset:128
    buffer_load_ushort v18, v3, s[8:11], s5 offen offset:256
    buffer_load_ushort v34, v3, s[20:23], 0 offen offset:256
    buffer_load_ushort v19, v3, s[8:11], s5 offen offset:384
    buffer_load_ushort v35, v3, s[20:23], 0 offen offset:384
    buffer_load_ushort v20, v3, s[8:11], s5 offen offset:512
    buffer_load_ushort v36, v3, s[20:23], 0 offen offset:512
    buffer_load_ushort v21, v3, s[8:11], s5 offen offset:640
    buffer_load_ushort v37, v3, s[20:23], 0 offen offset:640
    buffer_load_ushort v22, v3, s[8:11], s5 offen offset:768
    buffer_load_ushort v38, v3, s[20:23], 0 offen offset:768
    buffer_load_ushort v23, v3, s[8:11], s5 offen offset:896
    buffer_load_ushort v39, v3, s[20:23], 0 offen offset:896
    buffer_load_ushort v24, v3, s[8:11], s5 offen offset:1024
    buffer_load_ushort v40, v3, s[20:23], 0 offen offset:1024
    s_waitcnt vmcnt(0)
    v_lshlrev_b32 v16, 16, v16
    v_lshlrev_b32 v32, 16, v32
    v_mul_f32 v16, v16, v32
    v_cvt_pk_bf16_f32 v16, v16, v16
    v_lshlrev_b32 v16, 16, v16
    v_add_f32 v5, v5, v16
    v_lshlrev_b32 v17, 16, v17
    v_lshlrev_b32 v33, 16, v33
    v_mul_f32 v17, v17, v33
    v_cvt_pk_bf16_f32 v17, v17, v17
    v_lshlrev_b32 v17, 16, v17
    v_add_f32 v5, v5, v17
    v_lshlrev_b32 v18, 16, v18
    v_lshlrev_b32 v34, 16, v34
    v_mul_f32 v18, v18, v34
    v_cvt_pk_bf16_f32 v18, v18, v18
    v_lshlrev_b32 v18, 16, v18
    v_add_f32 v5, v5, v18
    v_lshlrev_b32 v19, 16, v19
    v_lshlrev_b32 v35, 16, v35
    v_mul_f32 v19, v19, v35
    v_cvt_pk_bf16_f32 v19, v19, v19
    v_lshlrev_b32 v19, 16, v19
    v_add_f32 v5, v5, v19
    v_lshlrev_b32 v20, 16, v20
    v_lshlrev_b32 v36, 16, v36
    v_mul_f32 v20, v20, v36
    v_cvt_pk_bf16_f32 v20, v20, v20
    v_lshlrev_b32 v20, 16, v20
    v_add_f32 v5, v5, v20
    v_lshlrev_b32 v21, 16, v21
    v_lshlrev_b32 v37, 16, v37
    v_mul_f32 v21, v21, v37
    v_cvt_pk_bf16_f32 v21, v21, v21
    v_lshlrev_b32 v21, 16, v21
    v_add_f32 v5, v5, v21
    v_lshlrev_b32 v22, 16, v22
    v_lshlrev_b32 v38, 16, v38
    v_mul_f32 v22, v22, v38
    v_cvt_pk_bf16_f32 v22, v22, v22
    v_lshlrev_b32 v22, 16, v22
    v_add_f32 v5, v5, v22
    v_lshlrev_b32 v23, 16, v23
    v_lshlrev_b32 v39, 16, v39
    v_mul_f32 v23, v23, v39
    v_cvt_pk_bf16_f32 v23, v23, v23
    v_lshlrev_b32 v23, 16, v23
    v_add_f32 v5, v5, v23
    v_lshlrev_b32 v24, 16, v24
    v_lshlrev_b32 v40, 16, v40
    v_mul_f32 v24, v24, v40
    v_cvt_pk_bf16_f32 v24, v24, v24
    v_lshlrev_b32 v24, 16, v24
    v_add_f32 v5, v5, v24
    v_xor_b32 v6, 4, v4
    ds_bpermute_b32 v7, v6, v5
    s_waitcnt lgkmcnt(0)
    v_add_f32 v5, v5, v7
    v_xor_b32 v6, 8, v4
    ds_bpermute_b32 v7, v6, v5
    s_waitcnt lgkmcnt(0)
    v_add_f32 v5, v5, v7
    v_xor_b32 v6, 16, v4
    ds_bpermute_b32 v7, v6, v5
    s_waitcnt lgkmcnt(0)
    v_add_f32 v5, v5, v7
    v_xor_b32 v6, 32, v4
    ds_bpermute_b32 v7, v6, v5
    s_waitcnt lgkmcnt(0)
    v_add_f32 v5, v5, v7
    v_xor_b32 v6, 64, v4
    ds_bpermute_b32 v7, v6, v5
    s_waitcnt lgkmcnt(0)
    v_add_f32 v5, v5, v7
    v_xor_b32 v6, 128, v4
    ds_bpermute_b32 v7, v6, v5
    s_waitcnt lgkmcnt(0)
    v_add_f32 v5, v5, v7
    v_cvt_pk_bf16_f32 v5, v5, v5
    v_lshlrev_b32 v5, 16, v5
    v_mul_f32 v5, 0xbfb8aa3b, v5
    v_exp_f32 v5, v5
    s_nop 0
    v_add_f32 v5, 1.0, v5
    v_rcp_f32 v5, v5
    s_nop 0
    v_cvt_pk_bf16_f32 v5, v5, v5
    v_lshlrev_b32 v5, 16, v5
    v_sub_f32 v6, 1.0, v5
    v_cvt_pk_bf16_f32 v6, v6, v6
    v_lshlrev_b32 v6, 16, v6
    s_add_u32 s7, s6, 0
    buffer_load_dword v16, v4, s[12:15], s7 offen offset:0
    s_add_u32 s7, s6, 4718592
    buffer_load_dword v17, v4, s[12:15], s7 offen offset:0
    s_add_u32 s7, s6, 9437184
    buffer_load_dword v18, v4, s[12:15], s7 offen offset:0
    s_add_u32 s7, s6, 14155776
    buffer_load_dword v19, v4, s[12:15], s7 offen offset:0
    s_add_u32 s7, s6, 18874368
    buffer_load_dword v20, v4, s[12:15], s7 offen offset:0
    s_add_u32 s7, s6, 23592960
    buffer_load_dword v21, v4, s[12:15], s7 offen offset:0
    s_add_u32 s7, s6, 28311552
    buffer_load_dword v22, v4, s[12:15], s7 offen offset:0
    s_add_u32 s7, s6, 0
    buffer_load_dword v23, v4, s[12:15], s7 offen offset:256
    s_add_u32 s7, s6, 4718592
    buffer_load_dword v24, v4, s[12:15], s7 offen offset:256
    s_add_u32 s7, s6, 9437184
    buffer_load_dword v25, v4, s[12:15], s7 offen offset:256
    s_add_u32 s7, s6, 14155776
    buffer_load_dword v26, v4, s[12:15], s7 offen offset:256
    s_add_u32 s7, s6, 18874368
    buffer_load_dword v27, v4, s[12:15], s7 offen offset:256
    s_add_u32 s7, s6, 23592960
    buffer_load_dword v28, v4, s[12:15], s7 offen offset:256
    s_add_u32 s7, s6, 28311552
    buffer_load_dword v29, v4, s[12:15], s7 offen offset:256
    s_add_u32 s7, s6, 0
    buffer_load_dword v30, v4, s[12:15], s7 offen offset:512
    s_add_u32 s7, s6, 4718592
    buffer_load_dword v31, v4, s[12:15], s7 offen offset:512
    s_add_u32 s7, s6, 9437184
    buffer_load_dword v32, v4, s[12:15], s7 offen offset:512
    s_add_u32 s7, s6, 14155776
    buffer_load_dword v33, v4, s[12:15], s7 offen offset:512
    s_add_u32 s7, s6, 18874368
    buffer_load_dword v34, v4, s[12:15], s7 offen offset:512
    s_add_u32 s7, s6, 23592960
    buffer_load_dword v35, v4, s[12:15], s7 offen offset:512
    s_add_u32 s7, s6, 28311552
    buffer_load_dword v36, v4, s[12:15], s7 offen offset:512
    s_add_u32 s7, s6, 0
    buffer_load_dword v37, v4, s[12:15], s7 offen offset:768
    s_add_u32 s7, s6, 4718592
    buffer_load_dword v38, v4, s[12:15], s7 offen offset:768
    s_add_u32 s7, s6, 9437184
    buffer_load_dword v39, v4, s[12:15], s7 offen offset:768
    s_add_u32 s7, s6, 14155776
    buffer_load_dword v40, v4, s[12:15], s7 offen offset:768
    s_add_u32 s7, s6, 18874368
    buffer_load_dword v41, v4, s[12:15], s7 offen offset:768
    s_add_u32 s7, s6, 23592960
    buffer_load_dword v42, v4, s[12:15], s7 offen offset:768
    s_add_u32 s7, s6, 28311552
    buffer_load_dword v43, v4, s[12:15], s7 offen offset:768
    s_add_u32 s7, s6, 0
    buffer_load_dword v44, v4, s[12:15], s7 offen offset:1024
    s_add_u32 s7, s6, 4718592
    buffer_load_dword v45, v4, s[12:15], s7 offen offset:1024
    s_add_u32 s7, s6, 9437184
    buffer_load_dword v46, v4, s[12:15], s7 offen offset:1024
    s_add_u32 s7, s6, 14155776
    buffer_load_dword v47, v4, s[12:15], s7 offen offset:1024
    s_add_u32 s7, s6, 18874368
    buffer_load_dword v48, v4, s[12:15], s7 offen offset:1024
    s_add_u32 s7, s6, 23592960
    buffer_load_dword v49, v4, s[12:15], s7 offen offset:1024
    s_add_u32 s7, s6, 28311552
    buffer_load_dword v50, v4, s[12:15], s7 offen offset:1024
    s_add_u32 s7, s6, 0
    buffer_load_dword v51, v4, s[12:15], s7 offen offset:1280
    s_add_u32 s7, s6, 4718592
    buffer_load_dword v52, v4, s[12:15], s7 offen offset:1280
    s_add_u32 s7, s6, 9437184
    buffer_load_dword v53, v4, s[12:15], s7 offen offset:1280
    s_add_u32 s7, s6, 14155776
    buffer_load_dword v54, v4, s[12:15], s7 offen offset:1280
    s_add_u32 s7, s6, 18874368
    buffer_load_dword v55, v4, s[12:15], s7 offen offset:1280
    s_add_u32 s7, s6, 23592960
    buffer_load_dword v56, v4, s[12:15], s7 offen offset:1280
    s_add_u32 s7, s6, 28311552
    buffer_load_dword v57, v4, s[12:15], s7 offen offset:1280
    s_add_u32 s7, s6, 0
    buffer_load_dword v58, v4, s[12:15], s7 offen offset:1536
    s_add_u32 s7, s6, 4718592
    buffer_load_dword v59, v4, s[12:15], s7 offen offset:1536
    s_add_u32 s7, s6, 9437184
    buffer_load_dword v60, v4, s[12:15], s7 offen offset:1536
    s_add_u32 s7, s6, 14155776
    buffer_load_dword v61, v4, s[12:15], s7 offen offset:1536
    s_add_u32 s7, s6, 18874368
    buffer_load_dword v62, v4, s[12:15], s7 offen offset:1536
    s_add_u32 s7, s6, 23592960
    buffer_load_dword v63, v4, s[12:15], s7 offen offset:1536
    s_add_u32 s7, s6, 28311552
    buffer_load_dword v64, v4, s[12:15], s7 offen offset:1536
    s_add_u32 s7, s6, 0
    buffer_load_dword v65, v4, s[12:15], s7 offen offset:1792
    s_add_u32 s7, s6, 4718592
    buffer_load_dword v66, v4, s[12:15], s7 offen offset:1792
    s_add_u32 s7, s6, 9437184
    buffer_load_dword v67, v4, s[12:15], s7 offen offset:1792
    s_add_u32 s7, s6, 14155776
    buffer_load_dword v68, v4, s[12:15], s7 offen offset:1792
    s_add_u32 s7, s6, 18874368
    buffer_load_dword v69, v4, s[12:15], s7 offen offset:1792
    s_add_u32 s7, s6, 23592960
    buffer_load_dword v70, v4, s[12:15], s7 offen offset:1792
    s_add_u32 s7, s6, 28311552
    buffer_load_dword v71, v4, s[12:15], s7 offen offset:1792
    s_add_u32 s7, s6, 0
    buffer_load_dword v72, v4, s[12:15], s7 offen offset:2048
    s_add_u32 s7, s6, 4718592
    buffer_load_dword v73, v4, s[12:15], s7 offen offset:2048
    s_add_u32 s7, s6, 9437184
    buffer_load_dword v74, v4, s[12:15], s7 offen offset:2048
    s_add_u32 s7, s6, 14155776
    buffer_load_dword v75, v4, s[12:15], s7 offen offset:2048
    s_add_u32 s7, s6, 18874368
    buffer_load_dword v76, v4, s[12:15], s7 offen offset:2048
    s_add_u32 s7, s6, 23592960
    buffer_load_dword v77, v4, s[12:15], s7 offen offset:2048
    s_add_u32 s7, s6, 28311552
    buffer_load_dword v78, v4, s[12:15], s7 offen offset:2048
    s_waitcnt vmcnt(0)
    v_add_f32 v16, v16, v17
    v_add_f32 v16, v16, v18
    v_add_f32 v16, v16, v19
    v_add_f32 v16, v16, v20
    v_add_f32 v16, v16, v21
    v_cvt_pk_bf16_f32 v16, v16, v16
    v_lshlrev_b32 v16, 16, v16
    v_cvt_pk_bf16_f32 v22, v22, v22
    v_lshlrev_b32 v22, 16, v22
    v_mul_f32 v16, v16, v6
    v_mul_f32 v22, v22, v5
    v_cvt_pk_bf16_f32 v16, v16, v16
    v_lshlrev_b32 v16, 16, v16
    v_cvt_pk_bf16_f32 v22, v22, v22
    v_lshlrev_b32 v22, 16, v22
    v_add_f32 v16, v16, v22
    v_cvt_pk_bf16_f32 v16, v16, v16
    buffer_store_short v16, v3, s[24:27], s5 offen offset:0
    v_add_f32 v23, v23, v24
    v_add_f32 v23, v23, v25
    v_add_f32 v23, v23, v26
    v_add_f32 v23, v23, v27
    v_add_f32 v23, v23, v28
    v_cvt_pk_bf16_f32 v23, v23, v23
    v_lshlrev_b32 v23, 16, v23
    v_cvt_pk_bf16_f32 v29, v29, v29
    v_lshlrev_b32 v29, 16, v29
    v_mul_f32 v23, v23, v6
    v_mul_f32 v29, v29, v5
    v_cvt_pk_bf16_f32 v23, v23, v23
    v_lshlrev_b32 v23, 16, v23
    v_cvt_pk_bf16_f32 v29, v29, v29
    v_lshlrev_b32 v29, 16, v29
    v_add_f32 v23, v23, v29
    v_cvt_pk_bf16_f32 v23, v23, v23
    buffer_store_short v23, v3, s[24:27], s5 offen offset:128
    v_add_f32 v30, v30, v31
    v_add_f32 v30, v30, v32
    v_add_f32 v30, v30, v33
    v_add_f32 v30, v30, v34
    v_add_f32 v30, v30, v35
    v_cvt_pk_bf16_f32 v30, v30, v30
    v_lshlrev_b32 v30, 16, v30
    v_cvt_pk_bf16_f32 v36, v36, v36
    v_lshlrev_b32 v36, 16, v36
    v_mul_f32 v30, v30, v6
    v_mul_f32 v36, v36, v5
    v_cvt_pk_bf16_f32 v30, v30, v30
    v_lshlrev_b32 v30, 16, v30
    v_cvt_pk_bf16_f32 v36, v36, v36
    v_lshlrev_b32 v36, 16, v36
    v_add_f32 v30, v30, v36
    v_cvt_pk_bf16_f32 v30, v30, v30
    buffer_store_short v30, v3, s[24:27], s5 offen offset:256
    v_add_f32 v37, v37, v38
    v_add_f32 v37, v37, v39
    v_add_f32 v37, v37, v40
    v_add_f32 v37, v37, v41
    v_add_f32 v37, v37, v42
    v_cvt_pk_bf16_f32 v37, v37, v37
    v_lshlrev_b32 v37, 16, v37
    v_cvt_pk_bf16_f32 v43, v43, v43
    v_lshlrev_b32 v43, 16, v43
    v_mul_f32 v37, v37, v6
    v_mul_f32 v43, v43, v5
    v_cvt_pk_bf16_f32 v37, v37, v37
    v_lshlrev_b32 v37, 16, v37
    v_cvt_pk_bf16_f32 v43, v43, v43
    v_lshlrev_b32 v43, 16, v43
    v_add_f32 v37, v37, v43
    v_cvt_pk_bf16_f32 v37, v37, v37
    buffer_store_short v37, v3, s[24:27], s5 offen offset:384
    v_add_f32 v44, v44, v45
    v_add_f32 v44, v44, v46
    v_add_f32 v44, v44, v47
    v_add_f32 v44, v44, v48
    v_add_f32 v44, v44, v49
    v_cvt_pk_bf16_f32 v44, v44, v44
    v_lshlrev_b32 v44, 16, v44
    v_cvt_pk_bf16_f32 v50, v50, v50
    v_lshlrev_b32 v50, 16, v50
    v_mul_f32 v44, v44, v6
    v_mul_f32 v50, v50, v5
    v_cvt_pk_bf16_f32 v44, v44, v44
    v_lshlrev_b32 v44, 16, v44
    v_cvt_pk_bf16_f32 v50, v50, v50
    v_lshlrev_b32 v50, 16, v50
    v_add_f32 v44, v44, v50
    v_cvt_pk_bf16_f32 v44, v44, v44
    buffer_store_short v44, v3, s[24:27], s5 offen offset:512
    v_add_f32 v51, v51, v52
    v_add_f32 v51, v51, v53
    v_add_f32 v51, v51, v54
    v_add_f32 v51, v51, v55
    v_add_f32 v51, v51, v56
    v_cvt_pk_bf16_f32 v51, v51, v51
    v_lshlrev_b32 v51, 16, v51
    v_cvt_pk_bf16_f32 v57, v57, v57
    v_lshlrev_b32 v57, 16, v57
    v_mul_f32 v51, v51, v6
    v_mul_f32 v57, v57, v5
    v_cvt_pk_bf16_f32 v51, v51, v51
    v_lshlrev_b32 v51, 16, v51
    v_cvt_pk_bf16_f32 v57, v57, v57
    v_lshlrev_b32 v57, 16, v57
    v_add_f32 v51, v51, v57
    v_cvt_pk_bf16_f32 v51, v51, v51
    buffer_store_short v51, v3, s[24:27], s5 offen offset:640
    v_add_f32 v58, v58, v59
    v_add_f32 v58, v58, v60
    v_add_f32 v58, v58, v61
    v_add_f32 v58, v58, v62
    v_add_f32 v58, v58, v63
    v_cvt_pk_bf16_f32 v58, v58, v58
    v_lshlrev_b32 v58, 16, v58
    v_cvt_pk_bf16_f32 v64, v64, v64
    v_lshlrev_b32 v64, 16, v64
    v_mul_f32 v58, v58, v6
    v_mul_f32 v64, v64, v5
    v_cvt_pk_bf16_f32 v58, v58, v58
    v_lshlrev_b32 v58, 16, v58
    v_cvt_pk_bf16_f32 v64, v64, v64
    v_lshlrev_b32 v64, 16, v64
    v_add_f32 v58, v58, v64
    v_cvt_pk_bf16_f32 v58, v58, v58
    buffer_store_short v58, v3, s[24:27], s5 offen offset:768
    v_add_f32 v65, v65, v66
    v_add_f32 v65, v65, v67
    v_add_f32 v65, v65, v68
    v_add_f32 v65, v65, v69
    v_add_f32 v65, v65, v70
    v_cvt_pk_bf16_f32 v65, v65, v65
    v_lshlrev_b32 v65, 16, v65
    v_cvt_pk_bf16_f32 v71, v71, v71
    v_lshlrev_b32 v71, 16, v71
    v_mul_f32 v65, v65, v6
    v_mul_f32 v71, v71, v5
    v_cvt_pk_bf16_f32 v65, v65, v65
    v_lshlrev_b32 v65, 16, v65
    v_cvt_pk_bf16_f32 v71, v71, v71
    v_lshlrev_b32 v71, 16, v71
    v_add_f32 v65, v65, v71
    v_cvt_pk_bf16_f32 v65, v65, v65
    buffer_store_short v65, v3, s[24:27], s5 offen offset:896
    v_add_f32 v72, v72, v73
    v_add_f32 v72, v72, v74
    v_add_f32 v72, v72, v75
    v_add_f32 v72, v72, v76
    v_add_f32 v72, v72, v77
    v_cvt_pk_bf16_f32 v72, v72, v72
    v_lshlrev_b32 v72, 16, v72
    v_cvt_pk_bf16_f32 v78, v78, v78
    v_lshlrev_b32 v78, 16, v78
    v_mul_f32 v72, v72, v6
    v_mul_f32 v78, v78, v5
    v_cvt_pk_bf16_f32 v72, v72, v72
    v_lshlrev_b32 v72, 16, v72
    v_cvt_pk_bf16_f32 v78, v78, v78
    v_lshlrev_b32 v78, 16, v78
    v_add_f32 v72, v72, v78
    v_cvt_pk_bf16_f32 v72, v72, v72
    buffer_store_short v72, v3, s[24:27], s5 offen offset:1024
kfin_done:
    s_endpgm
.section .rodata,"a"
.p2align 6
.amdhsa_kernel k1_kernel
  .amdhsa_next_free_vgpr 184
  .amdhsa_next_free_sgpr 96
  .amdhsa_accum_offset 112
  .amdhsa_group_segment_fixed_size 0
  .amdhsa_kernarg_size 80
  .amdhsa_user_sgpr_count 2
  .amdhsa_user_sgpr_kernarg_segment_ptr 1
  .amdhsa_system_sgpr_workgroup_id_x 1
.end_amdhsa_kernel
.p2align 6
.amdhsa_kernel k2_kernel
  .amdhsa_next_free_vgpr 184
  .amdhsa_next_free_sgpr 96
  .amdhsa_accum_offset 112
  .amdhsa_group_segment_fixed_size 0
  .amdhsa_kernarg_size 80
  .amdhsa_user_sgpr_count 2
  .amdhsa_user_sgpr_kernarg_segment_ptr 1
  .amdhsa_system_sgpr_workgroup_id_x 1
.end_amdhsa_kernel
.p2align 6
.amdhsa_kernel kkv_kernel
  .amdhsa_next_free_vgpr 168
  .amdhsa_next_free_sgpr 96
  .amdhsa_accum_offset 168
  .amdhsa_group_segment_fixed_size 0
  .amdhsa_kernarg_size 80
  .amdhsa_user_sgpr_count 2
  .amdhsa_user_sgpr_kernarg_segment_ptr 1
  .amdhsa_system_sgpr_workgroup_id_x 1
.end_amdhsa_kernel
.p2align 6
.amdhsa_kernel ko_kernel
  .amdhsa_next_free_vgpr 168
  .amdhsa_next_free_sgpr 96
  .amdhsa_accum_offset 168
  .amdhsa_group_segment_fixed_size 0
  .amdhsa_kernarg_size 80
  .amdhsa_user_sgpr_count 2
  .amdhsa_user_sgpr_kernarg_segment_ptr 1
  .amdhsa_system_sgpr_workgroup_id_x 1
.end_amdhsa_kernel
.p2align 6
.amdhsa_kernel kfin_kernel
  .amdhsa_next_free_vgpr 168
  .amdhsa_next_free_sgpr 96
  .amdhsa_accum_offset 168
  .amdhsa_group_segment_fixed_size 0
  .amdhsa_kernarg_size 80
  .amdhsa_user_sgpr_count 2
  .amdhsa_user_sgpr_kernarg_segment_ptr 1
  .amdhsa_system_sgpr_workgroup_id_x 1
.end_amdhsa_kernel
```
